```python
import torch

def _softmax(x, axis=-1):
    return torch.softmax(x, dim=axis)

def _gelu(x):
    return torch.nn.functional.gelu(x, approximate='tanh')

def _silu(x):
    return torch.nn.functional.silu(x)

def _sigmoid(x):
    return torch.sigmoid(x)

def _layernorm(x, axis=-1, eps=1e-05):
    m = x.mean(dim=axis, keepdim=True)
    v = x.var(dim=axis, keepdim=True, unbiased=False)
    return (x - m) / torch.sqrt(v + eps)

def _scatter_add(tgt, idx, src, axis=0):
    return tgt.clone().index_add_(axis, idx, src)

def _segment_sum(src, seg, n):
    out = torch.zeros((n,) + src.shape[1:], dtype=src.dtype)
    return out.index_add_(0, seg, src)

def _pad(x, pw):
    flat = tuple((v for pair in reversed(pw) for v in pair))
    return torch.nn.functional.pad(x, flat)
kernel_name = 'standalone__tree_speculative_verify_tree_attention_over_candidate_token_tree__sampling'

def setup_inputs():

    _w = lambda a: (lambda t: t.to(torch.bfloat16) if t.is_floating_point() else t)(torch.as_tensor(a))
    B, Hq, Hkv, T, C, D = (16, 32, 8, 32, 4096, 128)
    tree_mask = torch.zeros((B, T, T), dtype=float)
    for b in range(B):
        parent = torch.zeros(T, dtype=torch.int64)
        for i in range(1, T):
            parent[i] = int(torch.randint(0, i, (1,)).item())
        for i in range(T):
            j = i
            tree_mask[b, i, j] = 1.0
            while j > 0:
                j = parent[j]
                tree_mask[b, i, j] = 1.0
    return {'q': _w((lambda *s: torch.randn(*s, dtype=torch.bfloat16) * 0.8)(B, Hq, T, D)), 'k_cache': _w((lambda *s: torch.randn(*s, dtype=torch.bfloat16) * 0.8)(B, Hkv, C, D)), 'v_cache': _w((lambda *s: torch.randn(*s, dtype=torch.bfloat16) * 0.05)(B, Hkv, C, D)), 'k_tree': _w((lambda *s: torch.randn(*s, dtype=torch.bfloat16) * 0.8)(B, Hkv, T, D)), 'v_tree': _w((lambda *s: torch.randn(*s, dtype=torch.bfloat16) * 0.05)(B, Hkv, T, D)), 'tree_mask': _w(tree_mask)}

def reference(q, k_cache, v_cache, k_tree, v_tree, tree_mask):
    B, Hq, T, D = q.shape
    Hkv, C = (k_cache.shape[1], k_cache.shape[2])
    rep = Hq // Hkv
    kc = (lambda x, n, axis: torch.repeat_interleave(x, n, dim=axis))(k_cache, rep, axis=1)
    vc = (lambda x, n, axis: torch.repeat_interleave(x, n, dim=axis))(v_cache, rep, axis=1)
    kt = (lambda x, n, axis: torch.repeat_interleave(x, n, dim=axis))(k_tree, rep, axis=1)
    vt = (lambda x, n, axis: torch.repeat_interleave(x, n, dim=axis))(v_tree, rep, axis=1)
    k = torch.concatenate([kc, kt], axis=2)
    v = torch.concatenate([vc, vt], axis=2)
    scale = D ** (-0.5)
    scores = torch.einsum('bhqd,bhkd->bhqk', q, k) * scale
    ctx_mask = torch.ones((B, 1, T, C), dtype=scores.dtype)
    tm = tree_mask[:, None, :, :].clone()
    full_mask = torch.concatenate([ctx_mask, tm], axis=-1)
    scores = scores + (1.0 - full_mask) * -1000000000.0
    p = _softmax(scores, axis=-1)
    return torch.einsum('bhqk,bhkd->bhqd', p, v)
```

```asm
; @launch grid=(256,1,1) block=(384,1,1) lds=163840
.amdgcn_target "amdgcn-amd-amdhsa--gfx950"
.text
.globl standalone__tree_speculative_verify_tree_attention_over_candidate_token_tree__sampling_kernel
.p2align 8
.type standalone__tree_speculative_verify_tree_attention_over_candidate_token_tree__sampling_kernel,@function
standalone__tree_speculative_verify_tree_attention_over_candidate_token_tree__sampling_kernel:
    s_cmp_ge_u32 s2, 256
    s_cbranch_scc1 L_done
    s_load_dwordx4 s[4:7], s[0:1], 0
    s_load_dwordx4 s[8:11], s[0:1], 16
    s_load_dwordx4 s[12:15], s[0:1], 32
    s_load_dwordx4 s[16:19], s[0:1], 48
    s_load_dwordx2 s[20:21], s[0:1], 64
    s_getpc_b64 s[76:77]
    v_lshlrev_b32 v2, 7, v0
    v_min_u32 v2, (L_end-standalone__tree_speculative_verify_tree_attention_over_candidate_token_tree__sampling_kernel-128), v2
    global_load_dword v112, v2, s[76:77]
    v_lshrrev_b32 v1, 6, v0
    v_and_b32 v0, 63, v0
    v_readfirstlane_b32 s22, v1
    s_and_b32 s25, s2, 7
    s_lshr_b32 s26, s2, 4
    s_lshl_b32 s25, s25, 4
    s_add_u32 s23, s25, s26
    s_bfe_u32 s24, s2, 0x10003
    v_mov_b32 v7, 139264
    s_cmp_lt_u32 s22, 4
    s_cbranch_scc1 L_compute
    s_setprio 3
    v_and_b32 v1, 15, v0
    v_lshrrev_b32 v2, 4, v0
    v_lshlrev_b32 v3, 8, v2
    v_xor_b32 v4, v1, v2
    v_xor_b32 v5, 0, v4
    v_lshl_add_u32 v160, v5, 4, v3
    v_xor_b32 v5, 4, v4
    v_lshl_add_u32 v161, v5, 4, v3
    v_xor_b32 v5, 8, v4
    v_lshl_add_u32 v162, v5, 4, v3
    v_xor_b32 v5, 12, v4
    v_lshl_add_u32 v163, v5, 4, v3
    v_lshlrev_b32 v4, 1, v2
    v_xor_b32 v4, v1, v4
    v_xor_b32 v5, 0, v4
    v_lshl_add_u32 v164, v5, 4, v3
    v_xor_b32 v5, 8, v4
    v_lshl_add_u32 v165, v5, 4, v3
    s_cmp_eq_u32 s22, 4
    s_cbranch_scc0 L_control
    s_mov_b32 s55, 0
    s_lshl_b32 s54, s24, 19
    s_mov_b32 s69, 16384
    s_sub_u32 s57, 1032192, s54
    s_lshl_b32 s26, s23, 20
    s_mov_b32 s30, 0x100000
    s_mov_b32 s31, 0x20000
    s_mov_b32 s34, 0x100000
    s_mov_b32 s35, 0x20000
    s_mov_b32 s52, 0
    s_and_b32 s63, s23, 3
    s_add_u32 s63, s63, 11
    s_cmp_eq_u32 s24, 1
    s_cselect_b32 s63, s63, -1
    s_cselect_b32 s58, 8, 8
    s_mov_b32 s74, 11
    s_mov_b32 s59, 11
    s_mov_b32 s62, -1
    s_mov_b32 s38, 0x400000
    s_mov_b32 s39, 0x20000
    s_lshl_b32 s60, s23, 15
    s_mov_b32 s27, 98304
    v_mov_b32 v168, 64
    v_mov_b32 v169, 64
    s_waitcnt lgkmcnt(0)
    s_mov_b32 s36, s4
    s_mov_b32 s37, s5
L_ld_q:
    s_mov_b32 m0, s27
    s_add_u32 s27, s27, 4096
    buffer_load_dwordx4 v160, s[36:39], s60 offen offset:0 nt lds
    buffer_load_dwordx4 v161, s[36:39], s60 offen offset:1024 nt lds
    buffer_load_dwordx4 v162, s[36:39], s60 offen offset:2048 nt lds
    buffer_load_dwordx4 v163, s[36:39], s60 offen offset:3072 nt lds
    s_add_u32 s60, s60, 4096
    s_cmp_lt_u32 s27, 131072
    s_cbranch_scc1 L_ld_q
    s_add_u32 s28, s6, s26
    s_addc_u32 s29, s7, 0
    s_add_u32 s32, s8, s26
    s_addc_u32 s33, s9, 0
    s_mov_b32 s40, s20
    s_mov_b32 s41, s21
    s_mov_b32 s42, 0
    s_mov_b32 s43, 0x20000
    s_and_b32 s25, s2, 15
    s_lshr_b32 s26, s2, 5
    s_lshl_b32 s26, s26, 4
    s_or_b32 s25, s25, s26
    s_mul_i32 s25, s25, 37
    s_and_b32 s25, s25, 127
    s_mul_i32 s67, s24, 0
    s_add_u32 s67, s67, s25
    s_lshr_b32 s56, s25, 1
    s_add_u32 s56, s56, 15
    s_bfe_u32 s25, s2, 0x10004
    s_lshl_b32 s25, s25, 7
    s_add_u32 s78, s18, s25
    s_addc_u32 s79, s19, 0
    s_mov_b32 s68, 1023
    s_mov_b32 s3, 0
    v_mov_b32 v168, s68
L_ld_issue:
    s_add_u32 m0, s55, 0
    s_add_u32 s25, s54, 0
    buffer_load_dwordx4 v160, s[28:31], s25 offen offset:0 nt lds
    s_waitcnt vmcnt(28)
    buffer_load_dwordx4 v161, s[28:31], s25 offen offset:1024 nt lds
    s_waitcnt vmcnt(28)
    s_bitcmp1_b32 s68, 8
    s_cbranch_scc0 L_ld_nd0_1
    buffer_load_dword v170, off, s[40:43], 0
    s_waitcnt vmcnt(28)
L_ld_nd0_1:
    buffer_load_dwordx4 v162, s[28:31], s25 offen offset:2048 nt lds
    s_waitcnt vmcnt(28)
    buffer_load_dwordx4 v163, s[28:31], s25 offen offset:3072 nt lds
    s_waitcnt vmcnt(28)
    s_bitcmp1_b32 s68, 0
    s_cbranch_scc0 L_ld_nd0_3
    buffer_load_dword v170, off, s[40:43], 0
    s_waitcnt vmcnt(28)
L_ld_nd0_3:
    s_sub_u32 s74, s74, 1
    s_cmp_lg_u32 s74, 0
    s_cbranch_scc1 L_ld_nb0
    s_call_b64 s[76:77], L_ld_bar
L_ld_nb0:
    s_add_u32 m0, s55, 4096
    s_add_u32 s25, s54, 4096
    buffer_load_dwordx4 v160, s[28:31], s25 offen offset:0 nt lds
    s_waitcnt vmcnt(28)
    buffer_load_dwordx4 v161, s[28:31], s25 offen offset:1024 nt lds
    s_waitcnt vmcnt(28)
    s_bitcmp1_b32 s68, 12
    s_cbranch_scc0 L_ld_nd1_1
    buffer_load_dword v170, off, s[40:43], 0
    s_waitcnt vmcnt(28)
L_ld_nd1_1:
    buffer_load_dwordx4 v162, s[28:31], s25 offen offset:2048 nt lds
    s_waitcnt vmcnt(28)
    buffer_load_dwordx4 v163, s[28:31], s25 offen offset:3072 nt lds
    s_waitcnt vmcnt(28)
    s_bitcmp1_b32 s68, 4
    s_cbranch_scc0 L_ld_nd1_3
    buffer_load_dword v170, off, s[40:43], 0
    s_waitcnt vmcnt(28)
L_ld_nd1_3:
    s_sub_u32 s74, s74, 1
    s_cmp_lg_u32 s74, 0
    s_cbranch_scc1 L_ld_nb1
    s_call_b64 s[76:77], L_ld_bar
L_ld_nb1:
    s_add_u32 m0, s55, 8192
    s_add_u32 s25, s54, 8192
    buffer_load_dwordx4 v160, s[28:31], s25 offen offset:0 nt lds
    s_waitcnt vmcnt(28)
    buffer_load_dwordx4 v161, s[28:31], s25 offen offset:1024 nt lds
    s_waitcnt vmcnt(28)
    s_bitcmp1_b32 s68, 10
    s_cbranch_scc0 L_ld_nd2_1
    buffer_load_dword v170, off, s[40:43], 0
    s_waitcnt vmcnt(28)
L_ld_nd2_1:
    buffer_load_dwordx4 v162, s[28:31], s25 offen offset:2048 nt lds
    s_waitcnt vmcnt(28)
    buffer_load_dwordx4 v163, s[28:31], s25 offen offset:3072 nt lds
    s_waitcnt vmcnt(28)
    s_bitcmp1_b32 s68, 2
    s_cbranch_scc0 L_ld_nd2_3
    buffer_load_dword v170, off, s[40:43], 0
    s_waitcnt vmcnt(28)
L_ld_nd2_3:
    s_sub_u32 s74, s74, 1
    s_cmp_lg_u32 s74, 0
    s_cbranch_scc1 L_ld_nb2
    s_call_b64 s[76:77], L_ld_bar
L_ld_nb2:
    s_add_u32 m0, s55, 12288
    s_add_u32 s25, s54, 12288
    buffer_load_dwordx4 v160, s[28:31], s25 offen offset:0 nt lds
    s_waitcnt vmcnt(28)
    buffer_load_dwordx4 v161, s[28:31], s25 offen offset:1024 nt lds
    s_waitcnt vmcnt(28)
    s_bitcmp1_b32 s68, 14
    s_cbranch_scc0 L_ld_nd3_1
    buffer_load_dword v170, off, s[40:43], 0
    s_waitcnt vmcnt(28)
L_ld_nd3_1:
    buffer_load_dwordx4 v162, s[28:31], s25 offen offset:2048 nt lds
    s_waitcnt vmcnt(28)
    buffer_load_dwordx4 v163, s[28:31], s25 offen offset:3072 nt lds
    s_waitcnt vmcnt(28)
    s_bitcmp1_b32 s68, 6
    s_cbranch_scc0 L_ld_nd3_3
    buffer_load_dword v170, off, s[40:43], 0
    s_waitcnt vmcnt(28)
L_ld_nd3_3:
    s_sub_u32 s74, s74, 1
    s_cmp_lg_u32 s74, 0
    s_cbranch_scc1 L_ld_nb3
    s_call_b64 s[76:77], L_ld_bar
L_ld_nb3:
    s_add_u32 m0, s55, 16384
    s_add_u32 s25, s54, 0
    buffer_load_dwordx4 v164, s[32:35], s25 offen offset:0 nt lds
    s_waitcnt vmcnt(28)
    buffer_load_dwordx4 v165, s[32:35], s25 offen offset:1024 nt lds
    s_waitcnt vmcnt(28)
    s_bitcmp1_b32 s68, 9
    s_cbranch_scc0 L_ld_nd4_1
    buffer_load_dword v170, off, s[40:43], 0
    s_waitcnt vmcnt(28)
L_ld_nd4_1:
    buffer_load_dwordx4 v164, s[32:35], s25 offen offset:2048 nt lds
    s_waitcnt vmcnt(28)
    buffer_load_dwordx4 v165, s[32:35], s25 offen offset:3072 nt lds
    s_waitcnt vmcnt(28)
    s_bitcmp1_b32 s68, 1
    s_cbranch_scc0 L_ld_nd4_3
    buffer_load_dword v170, off, s[40:43], 0
    s_waitcnt vmcnt(28)
L_ld_nd4_3:
    s_sub_u32 s74, s74, 1
    s_cmp_lg_u32 s74, 0
    s_cbranch_scc1 L_ld_nb4
    s_call_b64 s[76:77], L_ld_bar
L_ld_nb4:
    s_add_u32 m0, s55, 20480
    s_add_u32 s25, s54, 4096
    buffer_load_dwordx4 v164, s[32:35], s25 offen offset:0 nt lds
    s_waitcnt vmcnt(28)
    buffer_load_dwordx4 v165, s[32:35], s25 offen offset:1024 nt lds
    s_waitcnt vmcnt(28)
    s_bitcmp1_b32 s68, 13
    s_cbranch_scc0 L_ld_nd5_1
    buffer_load_dword v170, off, s[40:43], 0
    s_waitcnt vmcnt(28)
L_ld_nd5_1:
    buffer_load_dwordx4 v164, s[32:35], s25 offen offset:2048 nt lds
    s_waitcnt vmcnt(28)
    buffer_load_dwordx4 v165, s[32:35], s25 offen offset:3072 nt lds
    s_waitcnt vmcnt(28)
    s_bitcmp1_b32 s68, 5
    s_cbranch_scc0 L_ld_nd5_3
    buffer_load_dword v170, off, s[40:43], 0
    s_waitcnt vmcnt(28)
L_ld_nd5_3:
    s_sub_u32 s74, s74, 1
    s_cmp_lg_u32 s74, 0
    s_cbranch_scc1 L_ld_nb5
    s_call_b64 s[76:77], L_ld_bar
L_ld_nb5:
    s_add_u32 m0, s55, 24576
    s_add_u32 s25, s54, 8192
    buffer_load_dwordx4 v164, s[32:35], s25 offen offset:0 nt lds
    s_waitcnt vmcnt(28)
    buffer_load_dwordx4 v165, s[32:35], s25 offen offset:1024 nt lds
    s_waitcnt vmcnt(28)
    s_bitcmp1_b32 s68, 11
    s_cbranch_scc0 L_ld_nd6_1
    buffer_load_dword v170, off, s[40:43], 0
    s_waitcnt vmcnt(28)
L_ld_nd6_1:
    buffer_load_dwordx4 v164, s[32:35], s25 offen offset:2048 nt lds
    s_waitcnt vmcnt(28)
    buffer_load_dwordx4 v165, s[32:35], s25 offen offset:3072 nt lds
    s_waitcnt vmcnt(28)
    s_bitcmp1_b32 s68, 3
    s_cbranch_scc0 L_ld_nd6_3
    buffer_load_dword v170, off, s[40:43], 0
    s_waitcnt vmcnt(28)
L_ld_nd6_3:
    s_sub_u32 s74, s74, 1
    s_cmp_lg_u32 s74, 0
    s_cbranch_scc1 L_ld_nb6
    s_call_b64 s[76:77], L_ld_bar
L_ld_nb6:
    s_add_u32 m0, s55, 28672
    s_add_u32 s25, s54, 12288
    buffer_load_dwordx4 v164, s[32:35], s25 offen offset:0 nt lds
    s_waitcnt vmcnt(28)
    buffer_load_dwordx4 v165, s[32:35], s25 offen offset:1024 nt lds
    s_waitcnt vmcnt(28)
    s_bitcmp1_b32 s68, 15
    s_cbranch_scc0 L_ld_nd7_1
    buffer_load_dword v170, off, s[40:43], 0
    s_waitcnt vmcnt(28)
L_ld_nd7_1:
    buffer_load_dwordx4 v164, s[32:35], s25 offen offset:2048 nt lds
    s_waitcnt vmcnt(28)
    buffer_load_dwordx4 v165, s[32:35], s25 offen offset:3072 nt lds
    s_waitcnt vmcnt(28)
    s_bitcmp1_b32 s68, 7
    s_cbranch_scc0 L_ld_nd7_3
    buffer_load_dword v170, off, s[40:43], 0
    s_waitcnt vmcnt(28)
L_ld_nd7_3:
    s_sub_u32 s74, s74, 1
    s_cmp_lg_u32 s74, 0
    s_cbranch_scc1 L_ld_nb7
    s_call_b64 s[76:77], L_ld_bar
L_ld_nb7:
    s_add_u32 s54, s54, s69
    s_add_u32 s55, s55, 32768
    s_and_b32 s55, s55, 0x1ffff
    s_add_u32 s52, s52, 1
    s_cmp_eq_u32 s52, 32
    s_cselect_b32 s54, s57, s54
    s_cselect_b32 s69, 0xffffc000, s69
    s_waitcnt lgkmcnt(0)
    v_readfirstlane_b32 s68, v168
    s_cmp_eq_u32 s24, 0
    s_cselect_b32 s53, 31, 33
    s_cselect_b32 s26, 31, 31
    s_cmp_lt_u32 s52, s26
    s_cbranch_scc1 L_ld_issue
L_ld_tail:
    s_cmp_lt_u32 s52, s53
    s_cbranch_scc0 L_ld_t2
    s_add_u32 m0, s55, 0
    s_add_u32 s25, s54, 0
    buffer_load_dwordx4 v160, s[28:31], s25 offen offset:0 nt lds
    buffer_load_dwordx4 v161, s[28:31], s25 offen offset:1024 nt lds
    buffer_load_dwordx4 v162, s[28:31], s25 offen offset:2048 nt lds
    buffer_load_dwordx4 v163, s[28:31], s25 offen offset:3072 nt lds
    s_add_u32 m0, s55, 4096
    s_add_u32 s25, s54, 4096
    buffer_load_dwordx4 v160, s[28:31], s25 offen offset:0 nt lds
    buffer_load_dwordx4 v161, s[28:31], s25 offen offset:1024 nt lds
    buffer_load_dwordx4 v162, s[28:31], s25 offen offset:2048 nt lds
    buffer_load_dwordx4 v163, s[28:31], s25 offen offset:3072 nt lds
    s_add_u32 m0, s55, 8192
    s_add_u32 s25, s54, 8192
    buffer_load_dwordx4 v160, s[28:31], s25 offen offset:0 nt lds
    buffer_load_dwordx4 v161, s[28:31], s25 offen offset:1024 nt lds
    buffer_load_dwordx4 v162, s[28:31], s25 offen offset:2048 nt lds
    buffer_load_dwordx4 v163, s[28:31], s25 offen offset:3072 nt lds
    s_add_u32 m0, s55, 12288
    s_add_u32 s25, s54, 12288
    buffer_load_dwordx4 v160, s[28:31], s25 offen offset:0 nt lds
    buffer_load_dwordx4 v161, s[28:31], s25 offen offset:1024 nt lds
    buffer_load_dwordx4 v162, s[28:31], s25 offen offset:2048 nt lds
    buffer_load_dwordx4 v163, s[28:31], s25 offen offset:3072 nt lds
    s_add_u32 m0, s55, 16384
    s_add_u32 s25, s54, 0
    buffer_load_dwordx4 v164, s[32:35], s25 offen offset:0 nt lds
    buffer_load_dwordx4 v165, s[32:35], s25 offen offset:1024 nt lds
    buffer_load_dwordx4 v164, s[32:35], s25 offen offset:2048 nt lds
    buffer_load_dwordx4 v165, s[32:35], s25 offen offset:3072 nt lds
    s_add_u32 m0, s55, 20480
    s_add_u32 s25, s54, 4096
    buffer_load_dwordx4 v164, s[32:35], s25 offen offset:0 nt lds
    buffer_load_dwordx4 v165, s[32:35], s25 offen offset:1024 nt lds
    buffer_load_dwordx4 v164, s[32:35], s25 offen offset:2048 nt lds
    buffer_load_dwordx4 v165, s[32:35], s25 offen offset:3072 nt lds
    s_add_u32 m0, s55, 24576
    s_add_u32 s25, s54, 8192
    buffer_load_dwordx4 v164, s[32:35], s25 offen offset:0 nt lds
    buffer_load_dwordx4 v165, s[32:35], s25 offen offset:1024 nt lds
    buffer_load_dwordx4 v164, s[32:35], s25 offen offset:2048 nt lds
    buffer_load_dwordx4 v165, s[32:35], s25 offen offset:3072 nt lds
    s_add_u32 m0, s55, 28672
    s_add_u32 s25, s54, 12288
    buffer_load_dwordx4 v164, s[32:35], s25 offen offset:0 nt lds
    buffer_load_dwordx4 v165, s[32:35], s25 offen offset:1024 nt lds
    buffer_load_dwordx4 v164, s[32:35], s25 offen offset:2048 nt lds
    buffer_load_dwordx4 v165, s[32:35], s25 offen offset:3072 nt lds
    s_add_u32 s54, s54, s69
    s_add_u32 s55, s55, 32768
    s_and_b32 s55, s55, 0x1ffff
    s_add_u32 s52, s52, 1
    s_cmp_eq_u32 s52, 32
    s_cselect_b32 s54, s57, s54
    s_cselect_b32 s69, 0xffffc000, s69
    s_add_u32 s62, s62, 1
    s_waitcnt vmcnt(32)
    s_barrier
    s_branch L_ld_tail
L_ld_t2:
    s_sub_u32 s52, s52, 1
L_ld_rest:
    s_cmp_ge_u32 s62, s52
    s_cbranch_scc1 L_ld_last
    s_barrier
    s_add_u32 s62, s62, 1
    s_branch L_ld_rest
L_ld_last:
    s_waitcnt vmcnt(0)
    s_barrier
    s_branch L_fin
L_ld_bar:
    s_barrier
    ds_read_b32 v168, v7 offset:8
    s_add_u32 s62, s62, 1
    s_mov_b32 s27, s59
    s_sub_u32 s26, s59, 1
    s_max_i32 s26, s26, 7
    s_cmp_ge_u32 s62, 6
    s_cselect_b32 s59, s26, s59
    s_cmp_eq_u32 s62, 0
    s_cselect_b32 s59, s58, s59
    s_cmp_eq_u32 s62, 1
    s_cselect_b32 s59, 12, s59
    s_add_u32 s26, s27, 9
    s_min_u32 s26, s26, 16
    s_cmp_eq_u32 s62, s63
    s_cselect_b32 s59, s26, s59
    s_sub_u32 s74, s59, s27
    s_add_u32 s74, s74, 8
    s_setpc_b64 s[76:77]
L_ld_chk:
    s_xor_b32 s3, s3, 1
    s_cbranch_scc0 L_ld_chk2
    s_mov_b32 s75, 1
    s_atomic_add s75, s[78:79], 0x0 glc
    s_mov_b32 s56, 11
    s_setpc_b64 s[76:77]
L_ld_chk2:
    s_waitcnt lgkmcnt(0)
    s_sub_i32 s25, s75, s67
    s_add_u32 s67, s67, 128
    s_mul_i32 s25, s25, 4
    s_add_i32 s25, s25, 8
    s_ashr_i32 s25, s25, 4
    s_sub_i32 s25, 10, s25
    s_max_i32 s25, s25, 0
    s_min_i32 s25, s25, 16
    s_bfm_b32 s68, s25, 0
    s_mov_b32 s56, 51
    s_setpc_b64 s[76:77]
L_compute:
    v_and_b32 v2, 15, v0
    v_lshrrev_b32 v3, 4, v0
    v_lshlrev_b32 v4, 8, v2
    s_lshl_b32 s60, s23, 2
    s_add_u32 s60, s60, s22
    s_lshl_b32 s60, s60, 13
    v_xor_b32 v5, v2, v3
    v_xor_b32 v1, 0, v5
    v_lshl_add_u32 v8, v1, 4, v4
    v_xor_b32 v1, 4, v5
    v_lshl_add_u32 v9, v1, 4, v4
    v_xor_b32 v1, 8, v5
    v_lshl_add_u32 v10, v1, 4, v4
    v_xor_b32 v1, 12, v5
    v_lshl_add_u32 v11, v1, 4, v4
    v_lshrrev_b32 v4, 2, v0
    v_and_b32 v5, 3, v0
    v_lshlrev_b32 v5, 3, v5
    v_lshl_add_u32 v5, v4, 8, v5
    v_and_b32 v4, 7, v4
    v_xor_b32 v1, 0, v4
    v_lshl_add_u32 v12, v1, 5, v5
    v_xor_b32 v1, 1, v4
    v_lshl_add_u32 v13, v1, 5, v5
    v_xor_b32 v1, 2, v4
    v_lshl_add_u32 v14, v1, 5, v5
    v_xor_b32 v1, 3, v4
    v_lshl_add_u32 v15, v1, 5, v5
    v_xor_b32 v1, 4, v4
    v_lshl_add_u32 v16, v1, 5, v5
    v_xor_b32 v1, 5, v4
    v_lshl_add_u32 v17, v1, 5, v5
    v_xor_b32 v1, 6, v4
    v_lshl_add_u32 v18, v1, 5, v5
    v_xor_b32 v1, 7, v4
    v_lshl_add_u32 v19, v1, 5, v5
    s_mov_b32 s25, 0x3f803f80
    v_mov_b32 v28, s25
    v_mov_b32 v29, s25
    v_mov_b32 v30, s25
    v_mov_b32 v31, s25
    v_mov_b32 v32, 0
    v_mov_b32 v33, 0
    v_mov_b32 v34, 0
    v_mov_b32 v35, 0
    v_mov_b32 v36, 0
    v_mov_b32 v37, 0
    v_mov_b32 v38, 0
    v_mov_b32 v39, 0
    s_mov_b32 s48, 0x3e0293ee
    s_mov_b32 s49, s48
    s_mov_b32 s68, 0x40004000
    s_mov_b32 s65, 0xffff0000
    s_mov_b32 s58, 1
    s_mov_b32 s67, 0xff800000
    s_mov_b32 s57, 0
    s_mov_b32 s56, 0
    s_mov_b32 s64, 0
    s_mov_b32 s66, 0
    s_mov_b32 s70, -1
    s_mov_b32 s50, 32768
    s_mov_b32 s51, 0xfffe8000
    s_and_b32 s63, s23, 3
    s_add_u32 s63, s63, 11
    s_cmp_eq_u32 s24, 1
    s_cselect_b32 s63, s63, -1
    s_mov_b32 s52, 1
    s_lshl_b32 s25, s22, 13
    s_add_u32 s25, s25, 98304
    v_add_u32 v144, s25, v8
    v_add_u32 v145, s25, v9
    v_add_u32 v146, s25, v10
    v_add_u32 v147, s25, v11
    s_waitcnt vmcnt(0) lgkmcnt(0)
    s_barrier
    ds_read_b128 v[160:163], v144 offset:0
    ds_read_b128 v[164:167], v145 offset:0
    ds_read_b128 v[168:171], v146 offset:0
    ds_read_b128 v[172:175], v147 offset:0
    ds_read_b128 v[176:179], v144 offset:4096
    ds_read_b128 v[180:183], v145 offset:4096
    ds_read_b128 v[184:187], v146 offset:4096
    ds_read_b128 v[188:191], v147 offset:4096
    s_waitcnt lgkmcnt(7)
    v_lshlrev_b32 v20, 16, v160
    v_and_b32 v21, s65, v160
    v_pk_mul_f32 v[20:21], v[20:21], s[48:49]
    v_cvt_pk_bf16_f32 v160, v20, v21
    v_lshlrev_b32 v22, 16, v161
    v_and_b32 v23, s65, v161
    v_pk_mul_f32 v[22:23], v[22:23], s[48:49]
    v_cvt_pk_bf16_f32 v161, v22, v23
    v_lshlrev_b32 v24, 16, v162
    v_and_b32 v25, s65, v162
    v_pk_mul_f32 v[24:25], v[24:25], s[48:49]
    v_cvt_pk_bf16_f32 v162, v24, v25
    v_lshlrev_b32 v26, 16, v163
    v_and_b32 v27, s65, v163
    v_pk_mul_f32 v[26:27], v[26:27], s[48:49]
    v_cvt_pk_bf16_f32 v163, v26, v27
    s_waitcnt lgkmcnt(6)
    v_lshlrev_b32 v20, 16, v164
    v_and_b32 v21, s65, v164
    v_pk_mul_f32 v[20:21], v[20:21], s[48:49]
    v_cvt_pk_bf16_f32 v164, v20, v21
    v_lshlrev_b32 v22, 16, v165
    v_and_b32 v23, s65, v165
    v_pk_mul_f32 v[22:23], v[22:23], s[48:49]
    v_cvt_pk_bf16_f32 v165, v22, v23
    v_lshlrev_b32 v24, 16, v166
    v_and_b32 v25, s65, v166
    v_pk_mul_f32 v[24:25], v[24:25], s[48:49]
    v_cvt_pk_bf16_f32 v166, v24, v25
    v_lshlrev_b32 v26, 16, v167
    v_and_b32 v27, s65, v167
    v_pk_mul_f32 v[26:27], v[26:27], s[48:49]
    v_cvt_pk_bf16_f32 v167, v26, v27
    s_waitcnt lgkmcnt(5)
    v_lshlrev_b32 v20, 16, v168
    v_and_b32 v21, s65, v168
    v_pk_mul_f32 v[20:21], v[20:21], s[48:49]
    v_cvt_pk_bf16_f32 v168, v20, v21
    v_lshlrev_b32 v22, 16, v169
    v_and_b32 v23, s65, v169
    v_pk_mul_f32 v[22:23], v[22:23], s[48:49]
    v_cvt_pk_bf16_f32 v169, v22, v23
    v_lshlrev_b32 v24, 16, v170
    v_and_b32 v25, s65, v170
    v_pk_mul_f32 v[24:25], v[24:25], s[48:49]
    v_cvt_pk_bf16_f32 v170, v24, v25
    v_lshlrev_b32 v26, 16, v171
    v_and_b32 v27, s65, v171
    v_pk_mul_f32 v[26:27], v[26:27], s[48:49]
    v_cvt_pk_bf16_f32 v171, v26, v27
    s_waitcnt lgkmcnt(4)
    v_lshlrev_b32 v20, 16, v172
    v_and_b32 v21, s65, v172
    v_pk_mul_f32 v[20:21], v[20:21], s[48:49]
    v_cvt_pk_bf16_f32 v172, v20, v21
    v_lshlrev_b32 v22, 16, v173
    v_and_b32 v23, s65, v173
    v_pk_mul_f32 v[22:23], v[22:23], s[48:49]
    v_cvt_pk_bf16_f32 v173, v22, v23
    v_lshlrev_b32 v24, 16, v174
    v_and_b32 v25, s65, v174
    v_pk_mul_f32 v[24:25], v[24:25], s[48:49]
    v_cvt_pk_bf16_f32 v174, v24, v25
    v_lshlrev_b32 v26, 16, v175
    v_and_b32 v27, s65, v175
    v_pk_mul_f32 v[26:27], v[26:27], s[48:49]
    v_cvt_pk_bf16_f32 v175, v26, v27
    s_waitcnt lgkmcnt(3)
    v_lshlrev_b32 v20, 16, v176
    v_and_b32 v21, s65, v176
    v_pk_mul_f32 v[20:21], v[20:21], s[48:49]
    v_cvt_pk_bf16_f32 v176, v20, v21
    v_lshlrev_b32 v22, 16, v177
    v_and_b32 v23, s65, v177
    v_pk_mul_f32 v[22:23], v[22:23], s[48:49]
    v_cvt_pk_bf16_f32 v177, v22, v23
    v_lshlrev_b32 v24, 16, v178
    v_and_b32 v25, s65, v178
    v_pk_mul_f32 v[24:25], v[24:25], s[48:49]
    v_cvt_pk_bf16_f32 v178, v24, v25
    v_lshlrev_b32 v26, 16, v179
    v_and_b32 v27, s65, v179
    v_pk_mul_f32 v[26:27], v[26:27], s[48:49]
    v_cvt_pk_bf16_f32 v179, v26, v27
    s_waitcnt lgkmcnt(2)
    v_lshlrev_b32 v20, 16, v180
    v_and_b32 v21, s65, v180
    v_pk_mul_f32 v[20:21], v[20:21], s[48:49]
    v_cvt_pk_bf16_f32 v180, v20, v21
    v_lshlrev_b32 v22, 16, v181
    v_and_b32 v23, s65, v181
    v_pk_mul_f32 v[22:23], v[22:23], s[48:49]
    v_cvt_pk_bf16_f32 v181, v22, v23
    v_lshlrev_b32 v24, 16, v182
    v_and_b32 v25, s65, v182
    v_pk_mul_f32 v[24:25], v[24:25], s[48:49]
    v_cvt_pk_bf16_f32 v182, v24, v25
    v_lshlrev_b32 v26, 16, v183
    v_and_b32 v27, s65, v183
    v_pk_mul_f32 v[26:27], v[26:27], s[48:49]
    v_cvt_pk_bf16_f32 v183, v26, v27
    s_waitcnt lgkmcnt(1)
    v_lshlrev_b32 v20, 16, v184
    v_and_b32 v21, s65, v184
    v_pk_mul_f32 v[20:21], v[20:21], s[48:49]
    v_cvt_pk_bf16_f32 v184, v20, v21
    v_lshlrev_b32 v22, 16, v185
    v_and_b32 v23, s65, v185
    v_pk_mul_f32 v[22:23], v[22:23], s[48:49]
    v_cvt_pk_bf16_f32 v185, v22, v23
    v_lshlrev_b32 v24, 16, v186
    v_and_b32 v25, s65, v186
    v_pk_mul_f32 v[24:25], v[24:25], s[48:49]
    v_cvt_pk_bf16_f32 v186, v24, v25
    v_lshlrev_b32 v26, 16, v187
    v_and_b32 v27, s65, v187
    v_pk_mul_f32 v[26:27], v[26:27], s[48:49]
    v_cvt_pk_bf16_f32 v187, v26, v27
    s_waitcnt lgkmcnt(0)
    v_lshlrev_b32 v20, 16, v188
    v_and_b32 v21, s65, v188
    v_pk_mul_f32 v[20:21], v[20:21], s[48:49]
    v_cvt_pk_bf16_f32 v188, v20, v21
    v_lshlrev_b32 v22, 16, v189
    v_and_b32 v23, s65, v189
    v_pk_mul_f32 v[22:23], v[22:23], s[48:49]
    v_cvt_pk_bf16_f32 v189, v22, v23
    v_lshlrev_b32 v24, 16, v190
    v_and_b32 v25, s65, v190
    v_pk_mul_f32 v[24:25], v[24:25], s[48:49]
    v_cvt_pk_bf16_f32 v190, v24, v25
    v_lshlrev_b32 v26, 16, v191
    v_and_b32 v27, s65, v191
    v_pk_mul_f32 v[26:27], v[26:27], s[48:49]
    v_cvt_pk_bf16_f32 v191, v26, v27
.p2align 3
L_loop:
    s_waitcnt lgkmcnt(0)
    s_barrier
L_nobar:
    v_mfma_f32_16x16x32_bf16 v[40:43], v[28:31], v[152:155], v[40:43]
    ds_read_b128 a[0:3], v8 offset:0
    ds_read_b128 a[4:7], v9 offset:0
    v_mfma_f32_16x16x32_bf16 v[44:47], v[28:31], v[156:159], v[44:47]
    ds_read_b128 a[8:11], v10 offset:0
    ds_read_b128 a[12:15], v11 offset:0
    v_mfma_f32_16x16x32_bf16 v[48:51], a[32:35], v[152:155], v[48:51]
    ds_read_b128 a[16:19], v8 offset:4096
    ds_read_b128 a[20:23], v9 offset:4096
    v_mfma_f32_16x16x32_bf16 v[52:55], a[32:35], v[156:159], v[52:55]
    ds_read_b128 a[24:27], v10 offset:4096
    ds_read_b128 a[28:31], v11 offset:4096
    v_mfma_f32_16x16x32_bf16 v[56:59], a[36:39], v[152:155], v[56:59]
    ds_read_b128 a[32:35], v8 offset:8192
    v_add_u32 v12, s56, v12
    v_mfma_f32_16x16x32_bf16 v[60:63], a[36:39], v[156:159], v[60:63]
    ds_read_b32 v6, v7
    v_add_u32 v19, s56, v19
    v_mfma_f32_16x16x32_bf16 v[64:67], a[40:43], v[152:155], v[64:67]
    ds_read_b128 a[36:39], v9 offset:8192
    v_add_u32 v13, s56, v13
    v_mfma_f32_16x16x32_bf16 v[68:71], a[40:43], v[156:159], v[68:71]
    v_mfma_f32_16x16x32_bf16 v[72:75], a[44:47], v[152:155], v[72:75]
    ds_read_b128 a[40:43], v10 offset:8192
    v_add_u32 v14, s56, v14
    v_mfma_f32_16x16x32_bf16 v[76:79], a[44:47], v[156:159], v[76:79]
    v_mfma_f32_16x16x32_bf16 v[80:83], a[48:51], v[152:155], v[80:83]
    ds_read_b128 a[44:47], v11 offset:8192
    v_add_u32 v15, s56, v15
    v_mfma_f32_16x16x32_bf16 v[84:87], a[48:51], v[156:159], v[84:87]
    v_mfma_f32_16x16x32_bf16 v[88:91], a[52:55], v[152:155], v[88:91]
    ds_read_b128 a[48:51], v8 offset:12288
    v_add_u32 v16, s56, v16
    v_mfma_f32_16x16x32_bf16 v[92:95], a[52:55], v[156:159], v[92:95]
    v_mfma_f32_16x16x32_bf16 v[96:99], a[56:59], v[152:155], v[96:99]
    ds_read_b128 a[52:55], v9 offset:12288
    v_add_u32 v17, s56, v17
    v_mfma_f32_16x16x32_bf16 v[100:103], a[56:59], v[156:159], v[100:103]
    v_mfma_f32_16x16x32_bf16 v[104:107], a[60:63], v[152:155], v[104:107]
    ds_read_b128 a[56:59], v10 offset:12288
    v_add_u32 v18, s56, v18
    v_mfma_f32_16x16x32_bf16 v[108:111], a[60:63], v[156:159], v[108:111]
    s_waitcnt lgkmcnt(6)
    s_and_b32 s25, s52, 3
    v_mfma_f32_16x16x32_bf16 v[112:115], a[0:3], v[160:163], v[32:35]
    ds_read_b128 a[60:63], v11 offset:12288
    s_cselect_b32 s56, s50, s51
    v_mfma_f32_16x16x32_bf16 v[116:119], a[0:3], v[176:179], v[36:39]
    v_add_u32 v8, s56, v8
    v_add_u32 v9, s56, v9
    v_mfma_f32_16x16x32_bf16 v[112:115], a[4:7], v[164:167], v[112:115]
    ds_read_b64_tr_b16 a[0:1], v12 offset:16384
    v_add_u32 v10, s56, v10
    v_mfma_f32_16x16x32_bf16 v[116:119], a[4:7], v[180:183], v[116:119]
    ds_read_b64_tr_b16 a[2:3], v12 offset:20480
    v_add_u32 v11, s56, v11
    v_mfma_f32_16x16x32_bf16 v[112:115], a[8:11], v[168:171], v[112:115]
    ds_read_b64_tr_b16 a[4:5], v13 offset:16384
    s_add_u32 s52, s52, 1
    v_mfma_f32_16x16x32_bf16 v[116:119], a[8:11], v[184:187], v[116:119]
    ds_read_b64_tr_b16 a[6:7], v13 offset:20480
    v_mfma_f32_16x16x32_bf16 v[112:115], a[12:15], v[172:175], v[112:115]
    ds_read_b64_tr_b16 a[8:9], v14 offset:16384
    v_readfirstlane_b32 s53, v6
    v_mfma_f32_16x16x32_bf16 v[116:119], a[12:15], v[188:191], v[116:119]
    ds_read_b64_tr_b16 a[10:11], v14 offset:20480
    v_mfma_f32_16x16x32_bf16 v[120:123], a[16:19], v[160:163], v[32:35]
    ds_read_b64_tr_b16 a[12:13], v15 offset:16384
    v_mfma_f32_16x16x32_bf16 v[124:127], a[16:19], v[176:179], v[36:39]
    ds_read_b64_tr_b16 a[14:15], v15 offset:20480
    s_min_u32 s59, s53, s63
    v_mfma_f32_16x16x32_bf16 v[120:123], a[20:23], v[164:167], v[120:123]
    ds_read_b64_tr_b16 a[16:17], v16 offset:16384
    v_mfma_f32_16x16x32_bf16 v[124:127], a[20:23], v[180:183], v[124:127]
    ds_read_b64_tr_b16 a[18:19], v16 offset:20480
    v_mfma_f32_16x16x32_bf16 v[120:123], a[24:27], v[168:171], v[120:123]
    ds_read_b64_tr_b16 a[20:21], v17 offset:16384
    v_mfma_f32_16x16x32_bf16 v[124:127], a[24:27], v[184:187], v[124:127]
    ds_read_b64_tr_b16 a[22:23], v17 offset:20480
    v_mfma_f32_16x16x32_bf16 v[120:123], a[28:31], v[172:175], v[120:123]
    ds_read_b64_tr_b16 a[24:25], v18 offset:16384
    v_mfma_f32_16x16x32_bf16 v[124:127], a[28:31], v[188:191], v[124:127]
    ds_read_b64_tr_b16 a[26:27], v18 offset:20480
    s_waitcnt lgkmcnt(14)
    v_mfma_f32_16x16x32_bf16 v[128:131], a[32:35], v[160:163], v[32:35]
    ds_read_b64_tr_b16 a[28:29], v19 offset:16384
    v_exp_f32 v20, v112
    v_exp_f32 v21, v113
    v_mfma_f32_16x16x32_bf16 v[132:135], a[32:35], v[176:179], v[36:39]
    ds_read_b64_tr_b16 a[30:31], v19 offset:20480
    v_exp_f32 v22, v114
    v_mfma_f32_16x16x32_bf16 v[128:131], a[36:39], v[164:167], v[128:131]
    ds_read_b64_tr_b16 a[32:33], v12 offset:24576
    v_exp_f32 v23, v115
    v_cvt_pk_bf16_f32 v144, v20, v21
    v_mfma_f32_16x16x32_bf16 v[132:135], a[36:39], v[180:183], v[132:135]
    ds_read_b64_tr_b16 a[34:35], v12 offset:28672
    v_exp_f32 v24, v116
    v_exp_f32 v25, v117
    v_mfma_f32_16x16x32_bf16 v[128:131], a[40:43], v[168:171], v[128:131]
    ds_read_b64_tr_b16 a[36:37], v13 offset:24576
    v_cvt_pk_bf16_f32 v145, v22, v23
    v_exp_f32 v26, v118
    v_mfma_f32_16x16x32_bf16 v[132:135], a[40:43], v[184:187], v[132:135]
    ds_read_b64_tr_b16 a[38:39], v13 offset:28672
    v_exp_f32 v27, v119
    v_mfma_f32_16x16x32_bf16 v[128:131], a[44:47], v[172:175], v[128:131]
    ds_read_b64_tr_b16 a[40:41], v14 offset:24576
    v_cvt_pk_bf16_f32 v148, v24, v25
    v_exp_f32 v20, v120
    v_mfma_f32_16x16x32_bf16 v[132:135], a[44:47], v[188:191], v[132:135]
    ds_read_b64_tr_b16 a[42:43], v14 offset:28672
    v_exp_f32 v21, v121
    v_cvt_pk_bf16_f32 v149, v26, v27
    v_mfma_f32_16x16x32_bf16 v[136:139], a[48:51], v[160:163], v[32:35]
    ds_read_b64_tr_b16 a[44:45], v15 offset:24576
    v_or3_b32 v1, v144, v145, v148
    v_exp_f32 v22, v122
    v_mfma_f32_16x16x32_bf16 v[140:143], a[48:51], v[176:179], v[36:39]
    ds_read_b64_tr_b16 a[46:47], v15 offset:28672
    v_exp_f32 v23, v123
    v_cvt_pk_bf16_f32 v146, v20, v21
    v_mfma_f32_16x16x32_bf16 v[136:139], a[52:55], v[164:167], v[136:139]
    ds_read_b64_tr_b16 a[48:49], v16 offset:24576
    v_exp_f32 v24, v124
    v_exp_f32 v25, v125
    v_mfma_f32_16x16x32_bf16 v[140:143], a[52:55], v[180:183], v[140:143]
    ds_read_b64_tr_b16 a[50:51], v16 offset:28672
    v_cvt_pk_bf16_f32 v147, v22, v23
    v_or3_b32 v1, v1, v149, v146
    v_mfma_f32_16x16x32_bf16 v[136:139], a[56:59], v[168:171], v[136:139]
    ds_read_b64_tr_b16 a[52:53], v17 offset:24576
    v_exp_f32 v26, v126
    v_exp_f32 v27, v127
    v_mfma_f32_16x16x32_bf16 v[140:143], a[56:59], v[184:187], v[140:143]
    ds_read_b64_tr_b16 a[54:55], v17 offset:28672
    v_cvt_pk_bf16_f32 v150, v24, v25
    v_or3_b32 v1, v1, v147, v150
    v_mfma_f32_16x16x32_bf16 v[136:139], a[60:63], v[172:175], v[136:139]
    ds_read_b64_tr_b16 a[56:57], v18 offset:24576
    v_cvt_pk_bf16_f32 v151, v26, v27
    v_bitop3_b32 v1, v1, v151, s68 bitop3:0xa8
    v_cmp_ne_u32 vcc, s58, v1
    v_mfma_f32_16x16x32_bf16 v[140:143], a[60:63], v[188:191], v[140:143]
    ds_read_b64_tr_b16 a[58:59], v18 offset:28672
    s_waitcnt lgkmcnt(14)
    s_cbranch_vccnz L_rare0
L_ret0:
    v_mfma_f32_16x16x32_bf16 v[48:51], a[0:3], v[144:147], v[48:51]
    ds_read_b64_tr_b16 a[60:61], v19 offset:24576
    ds_read_b64_tr_b16 a[62:63], v19 offset:28672
    v_mfma_f32_16x16x32_bf16 v[52:55], a[0:3], v[148:151], v[52:55]
    v_exp_f32 v20, v128
    v_mfma_f32_16x16x32_bf16 v[56:59], a[4:7], v[144:147], v[56:59]
    v_exp_f32 v21, v129
    v_exp_f32 v22, v130
    v_mfma_f32_16x16x32_bf16 v[60:63], a[4:7], v[148:151], v[60:63]
    v_exp_f32 v23, v131
    v_mfma_f32_16x16x32_bf16 v[64:67], a[8:11], v[144:147], v[64:67]
    v_cvt_pk_bf16_f32 v152, v20, v21
    v_exp_f32 v24, v132
    v_mfma_f32_16x16x32_bf16 v[68:71], a[8:11], v[148:151], v[68:71]
    v_exp_f32 v25, v133
    v_cvt_pk_bf16_f32 v153, v22, v23
    v_mfma_f32_16x16x32_bf16 v[72:75], a[12:15], v[144:147], v[72:75]
    v_exp_f32 v26, v134
    v_mfma_f32_16x16x32_bf16 v[76:79], a[12:15], v[148:151], v[76:79]
    v_exp_f32 v27, v135
    v_cvt_pk_bf16_f32 v156, v24, v25
    v_mfma_f32_16x16x32_bf16 v[80:83], a[16:19], v[144:147], v[80:83]
    v_exp_f32 v20, v136
    v_exp_f32 v21, v137
    v_mfma_f32_16x16x32_bf16 v[84:87], a[16:19], v[148:151], v[84:87]
    v_cvt_pk_bf16_f32 v157, v26, v27
    v_or3_b32 v1, v152, v153, v156
    v_mfma_f32_16x16x32_bf16 v[88:91], a[20:23], v[144:147], v[88:91]
    v_exp_f32 v22, v138
    v_exp_f32 v23, v139
    v_mfma_f32_16x16x32_bf16 v[92:95], a[20:23], v[148:151], v[92:95]
    v_cvt_pk_bf16_f32 v154, v20, v21
    v_mfma_f32_16x16x32_bf16 v[96:99], a[24:27], v[144:147], v[96:99]
    v_exp_f32 v24, v140
    v_exp_f32 v25, v141
    v_mfma_f32_16x16x32_bf16 v[100:103], a[24:27], v[148:151], v[100:103]
    v_cvt_pk_bf16_f32 v155, v22, v23
    v_or3_b32 v1, v1, v157, v154
    v_mfma_f32_16x16x32_bf16 v[104:107], a[28:31], v[144:147], v[104:107]
    v_exp_f32 v26, v142
    v_exp_f32 v27, v143
    v_mfma_f32_16x16x32_bf16 v[108:111], a[28:31], v[148:151], v[108:111]
    v_cvt_pk_bf16_f32 v158, v24, v25
    v_or3_b32 v1, v1, v155, v158
    v_mfma_f32_16x16x32_bf16 v[40:43], v[28:31], v[144:147], v[40:43]
    v_cvt_pk_bf16_f32 v159, v26, v27
    v_bitop3_b32 v1, v1, v159, s68 bitop3:0xa8
    v_cmp_ne_u32 vcc, s58, v1
    v_mfma_f32_16x16x32_bf16 v[44:47], v[28:31], v[148:151], v[44:47]
    s_cmp_le_u32 s52, s59
    s_cbranch_vccnz L_rare1
    s_cbranch_scc1 L_loop
L_except:
    s_cmp_gt_u32 s52, s63
    s_cbranch_scc1 L_treectl
L_tail:
    s_waitcnt lgkmcnt(0)
    v_mfma_f32_16x16x32_bf16 v[40:43], v[28:31], v[152:155], v[40:43]
    s_lshl_b32 s26, s22, 13
    v_mfma_f32_16x16x32_bf16 v[44:47], v[28:31], v[156:159], v[44:47]
    s_lshl_b32 s27, s22, 10
    v_mfma_f32_16x16x32_bf16 v[48:51], a[32:35], v[152:155], v[48:51]
    v_lshlrev_b32 v5, 4, v0
    v_mfma_f32_16x16x32_bf16 v[52:55], a[32:35], v[156:159], v[52:55]
    v_mfma_f32_16x16x32_bf16 v[56:59], a[36:39], v[152:155], v[56:59]
    v_mfma_f32_16x16x32_bf16 v[60:63], a[36:39], v[156:159], v[60:63]
    v_mfma_f32_16x16x32_bf16 v[64:67], a[40:43], v[152:155], v[64:67]
    v_mfma_f32_16x16x32_bf16 v[68:71], a[40:43], v[156:159], v[68:71]
    v_mfma_f32_16x16x32_bf16 v[72:75], a[44:47], v[152:155], v[72:75]
    v_mfma_f32_16x16x32_bf16 v[76:79], a[44:47], v[156:159], v[76:79]
    v_mfma_f32_16x16x32_bf16 v[80:83], a[48:51], v[152:155], v[80:83]
    v_mfma_f32_16x16x32_bf16 v[84:87], a[48:51], v[156:159], v[84:87]
    v_mfma_f32_16x16x32_bf16 v[88:91], a[52:55], v[152:155], v[88:91]
    v_mfma_f32_16x16x32_bf16 v[92:95], a[52:55], v[156:159], v[92:95]
    v_mfma_f32_16x16x32_bf16 v[96:99], a[56:59], v[152:155], v[96:99]
    v_mfma_f32_16x16x32_bf16 v[100:103], a[56:59], v[156:159], v[100:103]
    v_mfma_f32_16x16x32_bf16 v[104:107], a[60:63], v[152:155], v[104:107]
    v_mfma_f32_16x16x32_bf16 v[108:111], a[60:63], v[156:159], v[108:111]
    s_cmp_eq_u32 s24, 0
    s_cbranch_scc0 L_owner
    s_mov_b32 s36, s20
    s_mov_b32 s37, s21
    s_and_b32 s38, s70, 4751360
    s_mov_b32 s39, 0x20000
    s_mul_i32 s25, s23, 37120
    s_add_u32 s27, s27, s25
    s_add_u32 s27, s27, 32768
    s_add_u32 s26, s26, s25
    v_mov_b32 v20, v32
    v_mov_b32 v21, v40
    v_mov_b32 v22, v36
    v_mov_b32 v23, v44
    buffer_store_dwordx4 v[20:23], v5, s[36:39], s27 offen sc1
    v_cvt_pk_bf16_f32 v112, v48, v49
    v_cvt_pk_bf16_f32 v113, v50, v51
    v_cvt_pk_bf16_f32 v114, v52, v53
    v_cvt_pk_bf16_f32 v115, v54, v55
    buffer_store_dwordx4 v[112:115], v5, s[36:39], s26 offen offset:0 sc1
    v_cvt_pk_bf16_f32 v116, v56, v57
    v_cvt_pk_bf16_f32 v117, v58, v59
    v_cvt_pk_bf16_f32 v118, v60, v61
    v_cvt_pk_bf16_f32 v119, v62, v63
    buffer_store_dwordx4 v[116:119], v5, s[36:39], s26 offen offset:1024 sc1
    v_cvt_pk_bf16_f32 v120, v64, v65
    v_cvt_pk_bf16_f32 v121, v66, v67
    v_cvt_pk_bf16_f32 v122, v68, v69
    v_cvt_pk_bf16_f32 v123, v70, v71
    buffer_store_dwordx4 v[120:123], v5, s[36:39], s26 offen offset:2048 sc1
    v_cvt_pk_bf16_f32 v124, v72, v73
    v_cvt_pk_bf16_f32 v125, v74, v75
    v_cvt_pk_bf16_f32 v126, v76, v77
    v_cvt_pk_bf16_f32 v127, v78, v79
    buffer_store_dwordx4 v[124:127], v5, s[36:39], s26 offen offset:3072 sc1
    v_cvt_pk_bf16_f32 v128, v80, v81
    v_cvt_pk_bf16_f32 v129, v82, v83
    v_cvt_pk_bf16_f32 v130, v84, v85
    v_cvt_pk_bf16_f32 v131, v86, v87
    s_add_u32 s26, s26, 4096
    buffer_store_dwordx4 v[128:131], v5, s[36:39], s26 offen offset:0 sc1
    v_cvt_pk_bf16_f32 v132, v88, v89
    v_cvt_pk_bf16_f32 v133, v90, v91
    v_cvt_pk_bf16_f32 v134, v92, v93
    v_cvt_pk_bf16_f32 v135, v94, v95
    buffer_store_dwordx4 v[132:135], v5, s[36:39], s26 offen offset:1024 sc1
    v_cvt_pk_bf16_f32 v136, v96, v97
    v_cvt_pk_bf16_f32 v137, v98, v99
    v_cvt_pk_bf16_f32 v138, v100, v101
    v_cvt_pk_bf16_f32 v139, v102, v103
    buffer_store_dwordx4 v[136:139], v5, s[36:39], s26 offen offset:2048 sc1
    v_cvt_pk_bf16_f32 v140, v104, v105
    v_cvt_pk_bf16_f32 v141, v106, v107
    v_cvt_pk_bf16_f32 v142, v108, v109
    v_cvt_pk_bf16_f32 v143, v110, v111
    buffer_store_dwordx4 v[140:143], v5, s[36:39], s26 offen offset:3072 sc1
    s_cmp_lg_u32 s66, 0
    s_cbranch_scc1 L_ct_back2
    s_waitcnt vmcnt(0)
    s_barrier
    s_branch L_fin
L_owner:
    s_and_b32 s25, s53, 3
    s_lshl_b32 s25, s25, 15
    s_add_u32 s26, s26, s25
    s_add_u32 s27, s27, 143360
    v_add_u32 v4, s27, v5
    v_add_u32 v5, s26, v5
    s_mov_b32 s36, s16
    s_mov_b32 s37, s17
    s_and_b32 s38, s70, 4194304
    s_mov_b32 s39, 0x20000
    s_add_u32 s26, s60, 4096
    v_lshlrev_b32 v8, 4, v0
    v_sub_u32 v16, v5, v8
    v_and_b32 v2, 15, v0
    v_lshrrev_b32 v3, 4, v0
    v_xor_b32 v11, v2, v3
    v_lshlrev_b32 v11, 4, v11
    v_lshl_add_u32 v11, v3, 8, v11
    v_add_u32 v11, v11, v16
    v_and_b32 v10, 1, v3
    v_lshrrev_b32 v3, 1, v3
    v_lshl_add_u32 v10, v10, 1, v3
    v_xor_b32 v10, v10, v2
    v_lshlrev_b32 v10, 4, v10
    v_lshl_add_u32 v10, v2, 8, v10
    v_add_u32 v10, v10, v16
    s_cmp_lg_u32 s66, 0
    s_cbranch_scc1 L_own2
    s_barrier
L_own2:
    ds_read_b128 v[20:23], v4
    ds_read_b128 v[112:115], v5 offset:0
    ds_read_b128 v[116:119], v5 offset:1024
    ds_read_b128 v[120:123], v5 offset:2048
    ds_read_b128 v[124:127], v5 offset:3072
    ds_read_b128 v[128:131], v5 offset:4096
    ds_read_b128 v[132:135], v5 offset:5120
    ds_read_b128 v[136:139], v5 offset:6144
    ds_read_b128 v[140:143], v5 offset:7168
    s_waitcnt lgkmcnt(8)
    v_min_f32 v24, v32, v20
    v_min_f32 v25, v36, v22
    v_sub_f32 v12, v24, v32
    v_sub_f32 v14, v24, v20
    v_sub_f32 v13, v25, v36
    v_sub_f32 v15, v25, v22
    v_exp_f32 v12, v12
    v_exp_f32 v14, v14
    v_exp_f32 v13, v13
    v_exp_f32 v15, v15
    v_mul_f32 v24, v12, v40
    v_mul_f32 v25, v13, v44
    v_fma_f32 v24, v14, v21, v24
    v_fma_f32 v25, v15, v23, v25
    v_rcp_f32 v24, v24
    v_rcp_f32 v25, v25
    s_nop 0
    v_mul_f32 v12, v12, v24
    v_mul_f32 v14, v14, v24
    v_mul_f32 v13, v13, v25
    v_mul_f32 v15, v15, v25
    s_waitcnt lgkmcnt(0)
    v_lshlrev_b32 v20, 16, v112
    v_and_b32 v21, s65, v112
    v_pk_mul_f32 v[48:49], v[48:49], v[12:13] op_sel_hi:[1,0]
    v_pk_fma_f32 v[20:21], v[20:21], v[14:15], v[48:49] op_sel_hi:[1,0,1]
    v_cvt_pk_bf16_f32 v144, v20, v21
    v_lshlrev_b32 v22, 16, v113
    v_and_b32 v23, s65, v113
    v_pk_mul_f32 v[50:51], v[50:51], v[12:13] op_sel_hi:[1,0]
    v_pk_fma_f32 v[22:23], v[22:23], v[14:15], v[50:51] op_sel_hi:[1,0,1]
    v_cvt_pk_bf16_f32 v145, v22, v23
    v_lshlrev_b32 v24, 16, v116
    v_and_b32 v25, s65, v116
    v_pk_mul_f32 v[56:57], v[56:57], v[12:13] op_sel_hi:[1,0]
    v_pk_fma_f32 v[24:25], v[24:25], v[14:15], v[56:57] op_sel_hi:[1,0,1]
    v_cvt_pk_bf16_f32 v146, v24, v25
    v_lshlrev_b32 v26, 16, v117
    v_and_b32 v27, s65, v117
    v_pk_mul_f32 v[58:59], v[58:59], v[12:13] op_sel_hi:[1,0]
    v_pk_fma_f32 v[26:27], v[26:27], v[14:15], v[58:59] op_sel_hi:[1,0,1]
    v_cvt_pk_bf16_f32 v147, v26, v27
    v_xor_b32 v9, 0, v10
    s_nop 0
    v_permlane16_swap_b32 v144, v146
    v_permlane16_swap_b32 v145, v147
    ds_write_b128 v9, v[144:147] offset:0
    v_lshlrev_b32 v20, 16, v120
    v_and_b32 v21, s65, v120
    v_pk_mul_f32 v[64:65], v[64:65], v[12:13] op_sel_hi:[1,0]
    v_pk_fma_f32 v[20:21], v[20:21], v[14:15], v[64:65] op_sel_hi:[1,0,1]
    v_cvt_pk_bf16_f32 v148, v20, v21
    v_lshlrev_b32 v22, 16, v121
    v_and_b32 v23, s65, v121
    v_pk_mul_f32 v[66:67], v[66:67], v[12:13] op_sel_hi:[1,0]
    v_pk_fma_f32 v[22:23], v[22:23], v[14:15], v[66:67] op_sel_hi:[1,0,1]
    v_cvt_pk_bf16_f32 v149, v22, v23
    v_lshlrev_b32 v24, 16, v124
    v_and_b32 v25, s65, v124
    v_pk_mul_f32 v[72:73], v[72:73], v[12:13] op_sel_hi:[1,0]
    v_pk_fma_f32 v[24:25], v[24:25], v[14:15], v[72:73] op_sel_hi:[1,0,1]
    v_cvt_pk_bf16_f32 v150, v24, v25
    v_lshlrev_b32 v26, 16, v125
    v_and_b32 v27, s65, v125
    v_pk_mul_f32 v[74:75], v[74:75], v[12:13] op_sel_hi:[1,0]
    v_pk_fma_f32 v[26:27], v[26:27], v[14:15], v[74:75] op_sel_hi:[1,0,1]
    v_cvt_pk_bf16_f32 v151, v26, v27
    v_xor_b32 v9, 64, v10
    s_nop 0
    v_permlane16_swap_b32 v148, v150
    v_permlane16_swap_b32 v149, v151
    ds_write_b128 v9, v[148:151] offset:0
    v_lshlrev_b32 v20, 16, v128
    v_and_b32 v21, s65, v128
    v_pk_mul_f32 v[80:81], v[80:81], v[12:13] op_sel_hi:[1,0]
    v_pk_fma_f32 v[20:21], v[20:21], v[14:15], v[80:81] op_sel_hi:[1,0,1]
    v_cvt_pk_bf16_f32 v152, v20, v21
    v_lshlrev_b32 v22, 16, v129
    v_and_b32 v23, s65, v129
    v_pk_mul_f32 v[82:83], v[82:83], v[12:13] op_sel_hi:[1,0]
    v_pk_fma_f32 v[22:23], v[22:23], v[14:15], v[82:83] op_sel_hi:[1,0,1]
    v_cvt_pk_bf16_f32 v153, v22, v23
    v_lshlrev_b32 v24, 16, v132
    v_and_b32 v25, s65, v132
    v_pk_mul_f32 v[88:89], v[88:89], v[12:13] op_sel_hi:[1,0]
    v_pk_fma_f32 v[24:25], v[24:25], v[14:15], v[88:89] op_sel_hi:[1,0,1]
    v_cvt_pk_bf16_f32 v154, v24, v25
    v_lshlrev_b32 v26, 16, v133
    v_and_b32 v27, s65, v133
    v_pk_mul_f32 v[90:91], v[90:91], v[12:13] op_sel_hi:[1,0]
    v_pk_fma_f32 v[26:27], v[26:27], v[14:15], v[90:91] op_sel_hi:[1,0,1]
    v_cvt_pk_bf16_f32 v155, v26, v27
    v_xor_b32 v9, 128, v10
    s_nop 0
    v_permlane16_swap_b32 v152, v154
    v_permlane16_swap_b32 v153, v155
    ds_write_b128 v9, v[152:155] offset:0
    v_lshlrev_b32 v20, 16, v136
    v_and_b32 v21, s65, v136
    v_pk_mul_f32 v[96:97], v[96:97], v[12:13] op_sel_hi:[1,0]
    v_pk_fma_f32 v[20:21], v[20:21], v[14:15], v[96:97] op_sel_hi:[1,0,1]
    v_cvt_pk_bf16_f32 v156, v20, v21
    v_lshlrev_b32 v22, 16, v137
    v_and_b32 v23, s65, v137
    v_pk_mul_f32 v[98:99], v[98:99], v[12:13] op_sel_hi:[1,0]
    v_pk_fma_f32 v[22:23], v[22:23], v[14:15], v[98:99] op_sel_hi:[1,0,1]
    v_cvt_pk_bf16_f32 v157, v22, v23
    v_lshlrev_b32 v24, 16, v140
    v_and_b32 v25, s65, v140
    v_pk_mul_f32 v[104:105], v[104:105], v[12:13] op_sel_hi:[1,0]
    v_pk_fma_f32 v[24:25], v[24:25], v[14:15], v[104:105] op_sel_hi:[1,0,1]
    v_cvt_pk_bf16_f32 v158, v24, v25
    v_lshlrev_b32 v26, 16, v141
    v_and_b32 v27, s65, v141
    v_pk_mul_f32 v[106:107], v[106:107], v[12:13] op_sel_hi:[1,0]
    v_pk_fma_f32 v[26:27], v[26:27], v[14:15], v[106:107] op_sel_hi:[1,0,1]
    v_cvt_pk_bf16_f32 v159, v26, v27
    v_xor_b32 v9, 192, v10
    s_nop 0
    v_permlane16_swap_b32 v156, v158
    v_permlane16_swap_b32 v157, v159
    ds_write_b128 v9, v[156:159] offset:0
    v_xor_b32 v9, 0, v11
    ds_read_b128 v[48:51], v9 offset:0
    v_xor_b32 v9, 64, v11
    ds_read_b128 v[64:67], v9 offset:1024
    v_xor_b32 v9, 128, v11
    ds_read_b128 v[80:83], v9 offset:2048
    v_xor_b32 v9, 192, v11
    ds_read_b128 v[96:99], v9 offset:3072
    v_lshlrev_b32 v20, 16, v114
    v_and_b32 v21, s65, v114
    v_pk_mul_f32 v[52:53], v[52:53], v[12:13] op_sel:[0,1]
    v_pk_fma_f32 v[20:21], v[20:21], v[14:15], v[52:53] op_sel:[0,1,0]
    v_cvt_pk_bf16_f32 v144, v20, v21
    v_lshlrev_b32 v22, 16, v115
    v_and_b32 v23, s65, v115
    v_pk_mul_f32 v[54:55], v[54:55], v[12:13] op_sel:[0,1]
    v_pk_fma_f32 v[22:23], v[22:23], v[14:15], v[54:55] op_sel:[0,1,0]
    v_cvt_pk_bf16_f32 v145, v22, v23
    v_lshlrev_b32 v24, 16, v118
    v_and_b32 v25, s65, v118
    v_pk_mul_f32 v[60:61], v[60:61], v[12:13] op_sel:[0,1]
    v_pk_fma_f32 v[24:25], v[24:25], v[14:15], v[60:61] op_sel:[0,1,0]
    v_cvt_pk_bf16_f32 v146, v24, v25
    v_lshlrev_b32 v26, 16, v119
    v_and_b32 v27, s65, v119
    v_pk_mul_f32 v[62:63], v[62:63], v[12:13] op_sel:[0,1]
    v_pk_fma_f32 v[26:27], v[26:27], v[14:15], v[62:63] op_sel:[0,1,0]
    v_cvt_pk_bf16_f32 v147, v26, v27
    v_xor_b32 v9, 0, v10
    s_nop 0
    v_permlane16_swap_b32 v144, v146
    v_permlane16_swap_b32 v145, v147
    ds_write_b128 v9, v[144:147] offset:4096
    s_waitcnt lgkmcnt(1)
    buffer_store_dwordx4 v[48:51], v8, s[36:39], s60 offen offset:0 sc0 sc1
    buffer_store_dwordx4 v[64:67], v8, s[36:39], s60 offen offset:1024 sc0 sc1
    buffer_store_dwordx4 v[80:83], v8, s[36:39], s60 offen offset:2048 sc0 sc1
    buffer_store_dwordx4 v[96:99], v8, s[36:39], s60 offen offset:3072 sc0 sc1
    v_lshlrev_b32 v20, 16, v122
    v_and_b32 v21, s65, v122
    v_pk_mul_f32 v[68:69], v[68:69], v[12:13] op_sel:[0,1]
    v_pk_fma_f32 v[20:21], v[20:21], v[14:15], v[68:69] op_sel:[0,1,0]
    v_cvt_pk_bf16_f32 v148, v20, v21
    v_lshlrev_b32 v22, 16, v123
    v_and_b32 v23, s65, v123
    v_pk_mul_f32 v[70:71], v[70:71], v[12:13] op_sel:[0,1]
    v_pk_fma_f32 v[22:23], v[22:23], v[14:15], v[70:71] op_sel:[0,1,0]
    v_cvt_pk_bf16_f32 v149, v22, v23
    v_lshlrev_b32 v24, 16, v126
    v_and_b32 v25, s65, v126
    v_pk_mul_f32 v[76:77], v[76:77], v[12:13] op_sel:[0,1]
    v_pk_fma_f32 v[24:25], v[24:25], v[14:15], v[76:77] op_sel:[0,1,0]
    v_cvt_pk_bf16_f32 v150, v24, v25
    v_lshlrev_b32 v26, 16, v127
    v_and_b32 v27, s65, v127
    v_pk_mul_f32 v[78:79], v[78:79], v[12:13] op_sel:[0,1]
    v_pk_fma_f32 v[26:27], v[26:27], v[14:15], v[78:79] op_sel:[0,1,0]
    v_cvt_pk_bf16_f32 v151, v26, v27
    v_xor_b32 v9, 64, v10
    s_nop 0
    v_permlane16_swap_b32 v148, v150
    v_permlane16_swap_b32 v149, v151
    ds_write_b128 v9, v[148:151] offset:4096
    v_lshlrev_b32 v20, 16, v130
    v_and_b32 v21, s65, v130
    v_pk_mul_f32 v[84:85], v[84:85], v[12:13] op_sel:[0,1]
    v_pk_fma_f32 v[20:21], v[20:21], v[14:15], v[84:85] op_sel:[0,1,0]
    v_cvt_pk_bf16_f32 v152, v20, v21
    v_lshlrev_b32 v22, 16, v131
    v_and_b32 v23, s65, v131
    v_pk_mul_f32 v[86:87], v[86:87], v[12:13] op_sel:[0,1]
    v_pk_fma_f32 v[22:23], v[22:23], v[14:15], v[86:87] op_sel:[0,1,0]
    v_cvt_pk_bf16_f32 v153, v22, v23
    v_lshlrev_b32 v24, 16, v134
    v_and_b32 v25, s65, v134
    v_pk_mul_f32 v[92:93], v[92:93], v[12:13] op_sel:[0,1]
    v_pk_fma_f32 v[24:25], v[24:25], v[14:15], v[92:93] op_sel:[0,1,0]
    v_cvt_pk_bf16_f32 v154, v24, v25
    v_lshlrev_b32 v26, 16, v135
    v_and_b32 v27, s65, v135
    v_pk_mul_f32 v[94:95], v[94:95], v[12:13] op_sel:[0,1]
    v_pk_fma_f32 v[26:27], v[26:27], v[14:15], v[94:95] op_sel:[0,1,0]
    v_cvt_pk_bf16_f32 v155, v26, v27
    v_xor_b32 v9, 128, v10
    s_nop 0
    v_permlane16_swap_b32 v152, v154
    v_permlane16_swap_b32 v153, v155
    ds_write_b128 v9, v[152:155] offset:4096
    v_lshlrev_b32 v20, 16, v138
    v_and_b32 v21, s65, v138
    v_pk_mul_f32 v[100:101], v[100:101], v[12:13] op_sel:[0,1]
    v_pk_fma_f32 v[20:21], v[20:21], v[14:15], v[100:101] op_sel:[0,1,0]
    v_cvt_pk_bf16_f32 v156, v20, v21
    v_lshlrev_b32 v22, 16, v139
    v_and_b32 v23, s65, v139
    v_pk_mul_f32 v[102:103], v[102:103], v[12:13] op_sel:[0,1]
    v_pk_fma_f32 v[22:23], v[22:23], v[14:15], v[102:103] op_sel:[0,1,0]
    v_cvt_pk_bf16_f32 v157, v22, v23
    v_lshlrev_b32 v24, 16, v142
    v_and_b32 v25, s65, v142
    v_pk_mul_f32 v[108:109], v[108:109], v[12:13] op_sel:[0,1]
    v_pk_fma_f32 v[24:25], v[24:25], v[14:15], v[108:109] op_sel:[0,1,0]
    v_cvt_pk_bf16_f32 v158, v24, v25
    v_lshlrev_b32 v26, 16, v143
    v_and_b32 v27, s65, v143
    v_pk_mul_f32 v[110:111], v[110:111], v[12:13] op_sel:[0,1]
    v_pk_fma_f32 v[26:27], v[26:27], v[14:15], v[110:111] op_sel:[0,1,0]
    v_cvt_pk_bf16_f32 v159, v26, v27
    v_xor_b32 v9, 192, v10
    s_nop 0
    v_permlane16_swap_b32 v156, v158
    v_permlane16_swap_b32 v157, v159
    ds_write_b128 v9, v[156:159] offset:4096
    v_xor_b32 v9, 0, v11
    ds_read_b128 v[56:59], v9 offset:4096
    v_xor_b32 v9, 64, v11
    ds_read_b128 v[72:75], v9 offset:5120
    v_xor_b32 v9, 128, v11
    ds_read_b128 v[88:91], v9 offset:6144
    v_xor_b32 v9, 192, v11
    ds_read_b128 v[104:107], v9 offset:7168
    s_waitcnt lgkmcnt(3)
    buffer_store_dwordx4 v[56:59], v8, s[36:39], s26 offen offset:0 sc0 sc1
    s_waitcnt lgkmcnt(2)
    buffer_store_dwordx4 v[72:75], v8, s[36:39], s26 offen offset:1024 sc0 sc1
    s_waitcnt lgkmcnt(1)
    buffer_store_dwordx4 v[88:91], v8, s[36:39], s26 offen offset:2048 sc0 sc1
    s_waitcnt lgkmcnt(0)
    buffer_store_dwordx4 v[104:107], v8, s[36:39], s26 offen offset:3072 sc0 sc1
    s_cmp_lg_u32 s66, 0
    s_cbranch_scc1 L_ct_back2
L_fin:
L_done:
    s_endpgm
L_rare0:
    s_nop 7
    s_cmp_lg_u32 s64, 0
    s_cbranch_scc1 L_tree0
L_tret0:
    v_max3_f32 v2, v112, v113, v114
    v_max3_f32 v2, v2, v115, v120
    v_max3_f32 v2, v2, v121, v122
    v_max_f32 v2, v2, v123
    v_mov_b32 v3, v2
    s_nop 1
    v_permlane16_swap_b32 v2, v3
    s_nop 1
    v_max_f32 v2, v2, v3
    v_mov_b32 v3, v2
    s_nop 1
    v_permlane32_swap_b32 v2, v3
    s_nop 1
    v_max_f32 v2, v2, v3
    v_add_f32 v2, 0x41000000, v2
    v_max_f32 v2, s67, v2
    v_max_f32 v3, 0, v2
    v_exp_f32 v3, -v3
    v_sub_f32 v32, v32, v2
    v_sub_f32 v33, v33, v2
    v_sub_f32 v34, v34, v2
    v_sub_f32 v35, v35, v2
    v_mul_f32 v3, s57, v3
    v_sub_f32 v112, v112, v2
    v_sub_f32 v113, v113, v2
    v_sub_f32 v114, v114, v2
    v_sub_f32 v115, v115, v2
    v_sub_f32 v120, v120, v2
    v_sub_f32 v121, v121, v2
    v_sub_f32 v122, v122, v2
    v_sub_f32 v123, v123, v2
    v_sub_f32 v128, v128, v2
    v_sub_f32 v129, v129, v2
    v_sub_f32 v130, v130, v2
    v_sub_f32 v131, v131, v2
    v_sub_f32 v136, v136, v2
    v_sub_f32 v137, v137, v2
    v_sub_f32 v138, v138, v2
    v_sub_f32 v139, v139, v2
    v_mul_legacy_f32 v40, v40, v3
    v_mul_legacy_f32 v41, v41, v3
    v_mul_legacy_f32 v42, v42, v3
    v_mul_legacy_f32 v43, v43, v3
    v_mul_legacy_f32 v48, v48, v3
    v_mul_legacy_f32 v49, v49, v3
    v_mul_legacy_f32 v50, v50, v3
    v_mul_legacy_f32 v51, v51, v3
    v_mul_legacy_f32 v56, v56, v3
    v_mul_legacy_f32 v57, v57, v3
    v_mul_legacy_f32 v58, v58, v3
    v_mul_legacy_f32 v59, v59, v3
    v_mul_legacy_f32 v64, v64, v3
    v_mul_legacy_f32 v65, v65, v3
    v_mul_legacy_f32 v66, v66, v3
    v_mul_legacy_f32 v67, v67, v3
    v_mul_legacy_f32 v72, v72, v3
    v_mul_legacy_f32 v73, v73, v3
    v_mul_legacy_f32 v74, v74, v3
    v_mul_legacy_f32 v75, v75, v3
    v_mul_legacy_f32 v80, v80, v3
    v_mul_legacy_f32 v81, v81, v3
    v_mul_legacy_f32 v82, v82, v3
    v_mul_legacy_f32 v83, v83, v3
    v_mul_legacy_f32 v88, v88, v3
    v_mul_legacy_f32 v89, v89, v3
    v_mul_legacy_f32 v90, v90, v3
    v_mul_legacy_f32 v91, v91, v3
    v_mul_legacy_f32 v96, v96, v3
    v_mul_legacy_f32 v97, v97, v3
    v_mul_legacy_f32 v98, v98, v3
    v_mul_legacy_f32 v99, v99, v3
    v_mul_legacy_f32 v104, v104, v3
    v_mul_legacy_f32 v105, v105, v3
    v_mul_legacy_f32 v106, v106, v3
    v_mul_legacy_f32 v107, v107, v3
    v_max3_f32 v2, v116, v117, v118
    v_max3_f32 v2, v2, v119, v124
    v_max3_f32 v2, v2, v125, v126
    v_max_f32 v2, v2, v127
    v_mov_b32 v3, v2
    s_nop 1
    v_permlane16_swap_b32 v2, v3
    s_nop 1
    v_max_f32 v2, v2, v3
    v_mov_b32 v3, v2
    s_nop 1
    v_permlane32_swap_b32 v2, v3
    s_nop 1
    v_max_f32 v2, v2, v3
    v_add_f32 v2, 0x41000000, v2
    v_max_f32 v2, s67, v2
    v_max_f32 v3, 0, v2
    v_exp_f32 v3, -v3
    v_sub_f32 v36, v36, v2
    v_sub_f32 v37, v37, v2
    v_sub_f32 v38, v38, v2
    v_sub_f32 v39, v39, v2
    v_mul_f32 v3, s57, v3
    v_sub_f32 v116, v116, v2
    v_sub_f32 v117, v117, v2
    v_sub_f32 v118, v118, v2
    v_sub_f32 v119, v119, v2
    v_sub_f32 v124, v124, v2
    v_sub_f32 v125, v125, v2
    v_sub_f32 v126, v126, v2
    v_sub_f32 v127, v127, v2
    v_sub_f32 v132, v132, v2
    v_sub_f32 v133, v133, v2
    v_sub_f32 v134, v134, v2
    v_sub_f32 v135, v135, v2
    v_sub_f32 v140, v140, v2
    v_sub_f32 v141, v141, v2
    v_sub_f32 v142, v142, v2
    v_sub_f32 v143, v143, v2
    v_mul_legacy_f32 v44, v44, v3
    v_mul_legacy_f32 v45, v45, v3
    v_mul_legacy_f32 v46, v46, v3
    v_mul_legacy_f32 v47, v47, v3
    v_mul_legacy_f32 v52, v52, v3
    v_mul_legacy_f32 v53, v53, v3
    v_mul_legacy_f32 v54, v54, v3
    v_mul_legacy_f32 v55, v55, v3
    v_mul_legacy_f32 v60, v60, v3
    v_mul_legacy_f32 v61, v61, v3
    v_mul_legacy_f32 v62, v62, v3
    v_mul_legacy_f32 v63, v63, v3
    v_mul_legacy_f32 v68, v68, v3
    v_mul_legacy_f32 v69, v69, v3
    v_mul_legacy_f32 v70, v70, v3
    v_mul_legacy_f32 v71, v71, v3
    v_mul_legacy_f32 v76, v76, v3
    v_mul_legacy_f32 v77, v77, v3
    v_mul_legacy_f32 v78, v78, v3
    v_mul_legacy_f32 v79, v79, v3
    v_mul_legacy_f32 v84, v84, v3
    v_mul_legacy_f32 v85, v85, v3
    v_mul_legacy_f32 v86, v86, v3
    v_mul_legacy_f32 v87, v87, v3
    v_mul_legacy_f32 v92, v92, v3
    v_mul_legacy_f32 v93, v93, v3
    v_mul_legacy_f32 v94, v94, v3
    v_mul_legacy_f32 v95, v95, v3
    v_mul_legacy_f32 v100, v100, v3
    v_mul_legacy_f32 v101, v101, v3
    v_mul_legacy_f32 v102, v102, v3
    v_mul_legacy_f32 v103, v103, v3
    v_mul_legacy_f32 v108, v108, v3
    v_mul_legacy_f32 v109, v109, v3
    v_mul_legacy_f32 v110, v110, v3
    v_mul_legacy_f32 v111, v111, v3
    v_exp_f32 v20, v112
    v_exp_f32 v21, v113
    v_exp_f32 v22, v114
    v_exp_f32 v23, v115
    v_cvt_pk_bf16_f32 v144, v20, v21
    v_exp_f32 v24, v116
    v_exp_f32 v25, v117
    v_cvt_pk_bf16_f32 v145, v22, v23
    v_exp_f32 v26, v118
    v_exp_f32 v27, v119
    v_cvt_pk_bf16_f32 v148, v24, v25
    v_exp_f32 v20, v120
    v_exp_f32 v21, v121
    v_cvt_pk_bf16_f32 v149, v26, v27
    v_exp_f32 v22, v122
    v_exp_f32 v23, v123
    v_cvt_pk_bf16_f32 v146, v20, v21
    v_exp_f32 v24, v124
    v_exp_f32 v25, v125
    v_cvt_pk_bf16_f32 v147, v22, v23
    v_exp_f32 v26, v126
    v_exp_f32 v27, v127
    v_cvt_pk_bf16_f32 v150, v24, v25
    v_cvt_pk_bf16_f32 v151, v26, v27
    s_mov_b32 s58, s64
    s_mov_b32 s67, 0
    s_mov_b32 s57, 1.0
    s_branch L_ret0
L_rare1:
    s_nop 7
    s_cmp_lg_u32 s64, 0
    s_cbranch_scc1 L_tree1
    v_max3_f32 v2, v128, v129, v130
    v_max3_f32 v2, v2, v131, v136
    v_max3_f32 v2, v2, v137, v138
    v_max_f32 v2, v2, v139
    v_mov_b32 v3, v2
    s_nop 1
    v_permlane16_swap_b32 v2, v3
    s_nop 1
    v_max_f32 v2, v2, v3
    v_mov_b32 v3, v2
    s_nop 1
    v_permlane32_swap_b32 v2, v3
    s_nop 1
    v_max_f32 v2, v2, v3
    v_add_f32 v2, 0x41000000, v2
    v_max_f32 v2, s67, v2
    v_max_f32 v3, 0, v2
    v_exp_f32 v3, -v3
    v_sub_f32 v32, v32, v2
    v_sub_f32 v33, v33, v2
    v_sub_f32 v34, v34, v2
    v_sub_f32 v35, v35, v2
    v_sub_f32 v128, v128, v2
    v_sub_f32 v129, v129, v2
    v_sub_f32 v130, v130, v2
    v_sub_f32 v131, v131, v2
    v_sub_f32 v136, v136, v2
    v_sub_f32 v137, v137, v2
    v_sub_f32 v138, v138, v2
    v_sub_f32 v139, v139, v2
    v_mul_f32 v40, v40, v3
    v_mul_f32 v41, v41, v3
    v_mul_f32 v42, v42, v3
    v_mul_f32 v43, v43, v3
    v_mul_f32 v48, v48, v3
    v_mul_f32 v49, v49, v3
    v_mul_f32 v50, v50, v3
    v_mul_f32 v51, v51, v3
    v_mul_f32 v56, v56, v3
    v_mul_f32 v57, v57, v3
    v_mul_f32 v58, v58, v3
    v_mul_f32 v59, v59, v3
    v_mul_f32 v64, v64, v3
    v_mul_f32 v65, v65, v3
    v_mul_f32 v66, v66, v3
    v_mul_f32 v67, v67, v3
    v_mul_f32 v72, v72, v3
    v_mul_f32 v73, v73, v3
    v_mul_f32 v74, v74, v3
    v_mul_f32 v75, v75, v3
    v_mul_f32 v80, v80, v3
    v_mul_f32 v81, v81, v3
    v_mul_f32 v82, v82, v3
    v_mul_f32 v83, v83, v3
    v_mul_f32 v88, v88, v3
    v_mul_f32 v89, v89, v3
    v_mul_f32 v90, v90, v3
    v_mul_f32 v91, v91, v3
    v_mul_f32 v96, v96, v3
    v_mul_f32 v97, v97, v3
    v_mul_f32 v98, v98, v3
    v_mul_f32 v99, v99, v3
    v_mul_f32 v104, v104, v3
    v_mul_f32 v105, v105, v3
    v_mul_f32 v106, v106, v3
    v_mul_f32 v107, v107, v3
    v_max3_f32 v2, v132, v133, v134
    v_max3_f32 v2, v2, v135, v140
    v_max3_f32 v2, v2, v141, v142
    v_max_f32 v2, v2, v143
    v_mov_b32 v3, v2
    s_nop 1
    v_permlane16_swap_b32 v2, v3
    s_nop 1
    v_max_f32 v2, v2, v3
    v_mov_b32 v3, v2
    s_nop 1
    v_permlane32_swap_b32 v2, v3
    s_nop 1
    v_max_f32 v2, v2, v3
    v_add_f32 v2, 0x41000000, v2
    v_max_f32 v2, s67, v2
    v_max_f32 v3, 0, v2
    v_exp_f32 v3, -v3
    v_sub_f32 v36, v36, v2
    v_sub_f32 v37, v37, v2
    v_sub_f32 v38, v38, v2
    v_sub_f32 v39, v39, v2
    v_sub_f32 v132, v132, v2
    v_sub_f32 v133, v133, v2
    v_sub_f32 v134, v134, v2
    v_sub_f32 v135, v135, v2
    v_sub_f32 v140, v140, v2
    v_sub_f32 v141, v141, v2
    v_sub_f32 v142, v142, v2
    v_sub_f32 v143, v143, v2
    v_mul_f32 v44, v44, v3
    v_mul_f32 v45, v45, v3
    v_mul_f32 v46, v46, v3
    v_mul_f32 v47, v47, v3
    v_mul_f32 v52, v52, v3
    v_mul_f32 v53, v53, v3
    v_mul_f32 v54, v54, v3
    v_mul_f32 v55, v55, v3
    v_mul_f32 v60, v60, v3
    v_mul_f32 v61, v61, v3
    v_mul_f32 v62, v62, v3
    v_mul_f32 v63, v63, v3
    v_mul_f32 v68, v68, v3
    v_mul_f32 v69, v69, v3
    v_mul_f32 v70, v70, v3
    v_mul_f32 v71, v71, v3
    v_mul_f32 v76, v76, v3
    v_mul_f32 v77, v77, v3
    v_mul_f32 v78, v78, v3
    v_mul_f32 v79, v79, v3
    v_mul_f32 v84, v84, v3
    v_mul_f32 v85, v85, v3
    v_mul_f32 v86, v86, v3
    v_mul_f32 v87, v87, v3
    v_mul_f32 v92, v92, v3
    v_mul_f32 v93, v93, v3
    v_mul_f32 v94, v94, v3
    v_mul_f32 v95, v95, v3
    v_mul_f32 v100, v100, v3
    v_mul_f32 v101, v101, v3
    v_mul_f32 v102, v102, v3
    v_mul_f32 v103, v103, v3
    v_mul_f32 v108, v108, v3
    v_mul_f32 v109, v109, v3
    v_mul_f32 v110, v110, v3
    v_mul_f32 v111, v111, v3
    v_exp_f32 v20, v128
    v_exp_f32 v21, v129
    v_exp_f32 v22, v130
    v_exp_f32 v23, v131
    v_cvt_pk_bf16_f32 v152, v20, v21
    v_exp_f32 v24, v132
    v_exp_f32 v25, v133
    v_cvt_pk_bf16_f32 v153, v22, v23
    v_exp_f32 v26, v134
    v_exp_f32 v27, v135
    v_cvt_pk_bf16_f32 v156, v24, v25
    v_exp_f32 v20, v136
    v_exp_f32 v21, v137
    v_cvt_pk_bf16_f32 v157, v26, v27
    v_exp_f32 v22, v138
    v_exp_f32 v23, v139
    v_cvt_pk_bf16_f32 v154, v20, v21
    v_exp_f32 v24, v140
    v_exp_f32 v25, v141
    v_cvt_pk_bf16_f32 v155, v22, v23
    v_exp_f32 v26, v142
    v_exp_f32 v27, v143
    v_cvt_pk_bf16_f32 v158, v24, v25
    v_cvt_pk_bf16_f32 v159, v26, v27
    s_nop 0
L_ret1:
    s_cmp_le_u32 s52, s59
    s_cbranch_scc1 L_loop
    s_branch L_except
L_treectl:
    s_cmp_lg_u32 s66, 0
    s_cbranch_scc1 L_ct_back1
    s_cmp_lg_u32 s64, 0
    s_cbranch_scc1 L_treeoff
    s_sub_u32 s52, s52, 1
    s_and_b32 s25, s52, 3
    s_lshl_b32 s25, s25, 15
    s_sub_u32 s25, 131072, s25
    v_add_u32 v8, s25, v8
    v_add_u32 v9, s25, v9
    v_add_u32 v10, s25, v10
    v_add_u32 v11, s25, v11
    s_add_u32 s56, s56, s25
    s_sub_u32 s50, 0, s25
    s_mov_b32 s51, s50
    s_mov_b32 s64, 1
    s_mov_b32 s58, 1
    s_waitcnt lgkmcnt(0)
    s_branch L_nobar
L_treeoff:
    s_mov_b32 s64, 0
    s_mov_b32 s58, 0
    s_mov_b32 s63, -1
    s_mov_b32 s50, 32768
    s_mov_b32 s51, 0xfffe8000
    s_branch L_loop
L_tree0:
    v_and_b32 v2, 15, v0
    v_lshlrev_b32 v2, 6, v2
    v_lshrrev_b32 v3, 4, v0
    v_lshl_add_u32 v2, v3, 3, v2
    v_add_u32 v2, 140288, v2
    ds_read_b64 v[144:145], v2 offset:0
    ds_read_b64 v[146:147], v2 offset:1024
    ds_read_b64 v[148:149], v2 offset:32
    ds_read_b64 v[150:151], v2 offset:1056
    s_mov_b32 s25, 0xceabfb8f
    s_waitcnt lgkmcnt(0)
    v_lshlrev_b32 v2, 16, v144
    v_and_b32 v3, s65, v144
    v_sub_f32 v2, 1.0, v2
    v_sub_f32 v3, 1.0, v3
    v_fma_f32 v112, v2, s25, v112
    v_fma_f32 v113, v3, s25, v113
    v_lshlrev_b32 v2, 16, v145
    v_and_b32 v3, s65, v145
    v_sub_f32 v2, 1.0, v2
    v_sub_f32 v3, 1.0, v3
    v_fma_f32 v114, v2, s25, v114
    v_fma_f32 v115, v3, s25, v115
    v_lshlrev_b32 v2, 16, v146
    v_and_b32 v3, s65, v146
    v_sub_f32 v2, 1.0, v2
    v_sub_f32 v3, 1.0, v3
    v_fma_f32 v116, v2, s25, v116
    v_fma_f32 v117, v3, s25, v117
    v_lshlrev_b32 v2, 16, v147
    v_and_b32 v3, s65, v147
    v_sub_f32 v2, 1.0, v2
    v_sub_f32 v3, 1.0, v3
    v_fma_f32 v118, v2, s25, v118
    v_fma_f32 v119, v3, s25, v119
    v_lshlrev_b32 v2, 16, v148
    v_and_b32 v3, s65, v148
    v_sub_f32 v2, 1.0, v2
    v_sub_f32 v3, 1.0, v3
    v_fma_f32 v120, v2, s25, v120
    v_fma_f32 v121, v3, s25, v121
    v_lshlrev_b32 v2, 16, v149
    v_and_b32 v3, s65, v149
    v_sub_f32 v2, 1.0, v2
    v_sub_f32 v3, 1.0, v3
    v_fma_f32 v122, v2, s25, v122
    v_fma_f32 v123, v3, s25, v123
    v_lshlrev_b32 v2, 16, v150
    v_and_b32 v3, s65, v150
    v_sub_f32 v2, 1.0, v2
    v_sub_f32 v3, 1.0, v3
    v_fma_f32 v124, v2, s25, v124
    v_fma_f32 v125, v3, s25, v125
    v_lshlrev_b32 v2, 16, v151
    v_and_b32 v3, s65, v151
    v_sub_f32 v2, 1.0, v2
    v_sub_f32 v3, 1.0, v3
    v_fma_f32 v126, v2, s25, v126
    v_fma_f32 v127, v3, s25, v127
    s_branch L_tret0
L_tree1:
    v_mov_b32 v152, 0
    v_mov_b32 v153, 0
    v_mov_b32 v154, 0
    v_mov_b32 v155, 0
    v_mov_b32 v156, 0
    v_mov_b32 v157, 0
    v_mov_b32 v158, 0
    v_mov_b32 v159, 0
    s_branch L_ret1
L_control:
    s_cmp_eq_u32 s24, 0
    s_cselect_b32 s25, 31, 33
    s_cselect_b32 s26, 31, 31
    v_mov_b32 v172, s25
    v_mov_b32 v173, s26
    ds_write_b64 v7, v[172:173]
    v_mov_b32 v172, 1023
    ds_write_b32 v7, v172 offset:8
    v_lshlrev_b32 v166, 4, v0
    s_mul_i32 s61, s23, 37120
    s_add_u32 s73, s61, 36864
    v_mov_b32 v168, 0
    v_mov_b32 v169, 0
    s_waitcnt lgkmcnt(0)
    s_cmp_lg_u32 s2, 0
    s_cbranch_scc1 L_ct_n0
    s_call_b64 s[76:77], L_ct_cas
L_ct_n0:
    s_mov_b32 s40, s20
    s_mov_b32 s41, s21
    s_mov_b32 s42, 6848512
    s_mov_b32 s43, 0x20000
    s_add_u32 s78, s20, s73
    s_addc_u32 s79, s21, 0
    s_mov_b32 s66, 1
    s_mov_b32 s70, 0
    s_mov_b32 s60, 0
    s_setprio 0
    v_mov_b32 v8, 0
    v_mov_b32 v9, 0
    v_mov_b32 v10, 0
    v_mov_b32 v11, 0
    v_mov_b32 v12, 0
    v_mov_b32 v13, 0
    v_mov_b32 v14, 0
    v_mov_b32 v15, 0
    v_mov_b32 v16, 0
    v_mov_b32 v17, 0
    v_mov_b32 v18, 0
    v_mov_b32 v19, 0
    s_mov_b32 s58, 1
    s_mov_b32 s64, 0
    s_mov_b32 s63, 0
    s_mov_b32 s52, 1
    s_mov_b32 s56, 0
    s_mov_b32 s50, 0
    s_mov_b32 s51, 0
    s_mov_b32 s68, 0
    s_branch L_nobar
L_ct_back1:
    s_setprio 3
    s_waitcnt lgkmcnt(0)
    s_barrier
    s_waitcnt vmcnt(0)
    s_barrier
    s_cmp_eq_u32 s24, 1
    s_cbranch_scc0 L_ct_notree
    s_lshl_b32 s26, s23, 13
    s_add_u32 s28, s10, s26
    s_addc_u32 s29, s11, 0
    s_mov_b32 s30, 8192
    s_mov_b32 s31, 0x20000
    s_add_u32 s32, s12, s26
    s_addc_u32 s33, s13, 0
    s_mov_b32 s34, 8192
    s_mov_b32 s35, 0x20000
    s_mov_b32 s36, s14
    s_mov_b32 s37, s15
    s_mov_b32 s38, 32768
    s_mov_b32 s39, 0x20000
    s_mov_b32 s55, 131072
    s_mov_b32 s54, 0
    s_add_u32 m0, s55, 0
    s_add_u32 s25, s54, 0
    buffer_load_dwordx4 v160, s[28:31], s25 offen offset:0 nt lds
    buffer_load_dwordx4 v161, s[28:31], s25 offen offset:1024 nt lds
    buffer_load_dwordx4 v162, s[28:31], s25 offen offset:2048 nt lds
    buffer_load_dwordx4 v163, s[28:31], s25 offen offset:3072 nt lds
    s_add_u32 m0, s55, 4096
    s_add_u32 s25, s54, 4096
    buffer_load_dwordx4 v160, s[28:31], s25 offen offset:0 nt lds
    buffer_load_dwordx4 v161, s[28:31], s25 offen offset:1024 nt lds
    buffer_load_dwordx4 v162, s[28:31], s25 offen offset:2048 nt lds
    buffer_load_dwordx4 v163, s[28:31], s25 offen offset:3072 nt lds
    s_add_u32 m0, s55, 16384
    s_add_u32 s25, s54, 0
    buffer_load_dwordx4 v164, s[32:35], s25 offen offset:0 nt lds
    buffer_load_dwordx4 v165, s[32:35], s25 offen offset:1024 nt lds
    buffer_load_dwordx4 v164, s[32:35], s25 offen offset:2048 nt lds
    buffer_load_dwordx4 v165, s[32:35], s25 offen offset:3072 nt lds
    s_add_u32 m0, s55, 20480
    s_add_u32 s25, s54, 4096
    buffer_load_dwordx4 v164, s[32:35], s25 offen offset:0 nt lds
    buffer_load_dwordx4 v165, s[32:35], s25 offen offset:1024 nt lds
    buffer_load_dwordx4 v164, s[32:35], s25 offen offset:2048 nt lds
    buffer_load_dwordx4 v165, s[32:35], s25 offen offset:3072 nt lds
    s_add_u32 m0, s55, 24576
    s_add_u32 s25, s54, 8192
    buffer_load_dwordx4 v164, s[32:35], s25 offen offset:0 nt lds
    buffer_load_dwordx4 v165, s[32:35], s25 offen offset:1024 nt lds
    buffer_load_dwordx4 v164, s[32:35], s25 offen offset:2048 nt lds
    buffer_load_dwordx4 v165, s[32:35], s25 offen offset:3072 nt lds
    s_add_u32 m0, s55, 28672
    s_add_u32 s25, s54, 12288
    buffer_load_dwordx4 v164, s[32:35], s25 offen offset:0 nt lds
    buffer_load_dwordx4 v165, s[32:35], s25 offen offset:1024 nt lds
    buffer_load_dwordx4 v164, s[32:35], s25 offen offset:2048 nt lds
    buffer_load_dwordx4 v165, s[32:35], s25 offen offset:3072 nt lds
    s_mov_b32 m0, 140288
    s_lshr_b32 s25, s23, 3
    s_lshl_b32 s25, s25, 11
    buffer_load_dwordx4 v166, s[36:39], s25 offen offset:0 nt lds
    buffer_load_dwordx4 v166, s[36:39], s25 offen offset:1024 nt lds
L_ct_notree:
    s_barrier
L_ct_back2:
    s_barrier
    s_mov_b64 exec, 1
    s_barrier
    s_memrealtime s[98:99]
    s_waitcnt lgkmcnt(0)
    s_cmp_lt_u32 s2, 8
    s_cbranch_scc0 L_fb_np0
    v_mov_b32 v172, s98
    s_lshl_b32 s25, s2, 12
    s_add_u32 s25, s25, 4751360
    buffer_store_dword v172, off, s[40:43], s25 sc1
L_fb_np0:
    s_load_dwordx2 s[96:97], s[18:19], 0xf8
    s_barrier
    s_waitcnt vmcnt(0) lgkmcnt(0)
    s_cmp_lg_u64 s[96:97], 0
    s_cbranch_scc1 L_ct_n1
    s_call_b64 s[76:77], L_ct_cas
L_ct_n1:
    v_mov_b32 v170, s96
    v_mov_b32 v171, s97
    s_barrier
    s_mov_b32 s25, 4751360
    s_call_b64 s[76:77], L_fb_eval
    s_barrier
    s_barrier
    s_memrealtime s[98:99]
    s_waitcnt lgkmcnt(0)
    s_cmp_lt_u32 s2, 8
    s_cbranch_scc0 L_fb_np1
    v_mov_b32 v172, s98
    s_lshl_b32 s25, s2, 12
    s_add_u32 s25, s25, 4820992
    buffer_store_dword v172, off, s[40:43], s25 sc1
L_fb_np1:
    s_barrier
    s_barrier
    s_mov_b32 s25, 4820992
    s_call_b64 s[76:77], L_fb_eval
    s_barrier
    s_barrier
    s_memrealtime s[98:99]
    s_and_b32 s25, s23, 3
    s_add_i32 s25, s25, 9
    s_max_i32 s25, s25, 0
    s_cmp_gt_i32 s25, 9
    s_cselect_b32 s25, 0, s25
    s_mul_i32 s25, s25, s24
    s_mul_i32 s25, s25, 14
    s_waitcnt lgkmcnt(0)
    s_sub_u32 s98, s98, s25
    s_cmp_lt_u32 s2, 8
    s_cbranch_scc0 L_fb_np2
    v_mov_b32 v172, s98
    s_lshl_b32 s25, s2, 12
    s_add_u32 s25, s25, 4890624
    buffer_store_dword v172, off, s[40:43], s25 sc1
L_fb_np2:
    s_barrier
    s_barrier
    s_mov_b32 s25, 4890624
    s_call_b64 s[76:77], L_fb_eval
    s_barrier
    s_barrier
    s_memrealtime s[98:99]
    s_and_b32 s25, s23, 3
    s_add_i32 s25, s25, 5
    s_max_i32 s25, s25, 0
    s_cmp_gt_i32 s25, 9
    s_cselect_b32 s25, 0, s25
    s_mul_i32 s25, s25, s24
    s_mul_i32 s25, s25, 14
    s_waitcnt lgkmcnt(0)
    s_sub_u32 s98, s98, s25
    s_cmp_lt_u32 s2, 8
    s_cbranch_scc0 L_fb_np3
    v_mov_b32 v172, s98
    s_lshl_b32 s25, s2, 12
    s_add_u32 s25, s25, 4960256
    buffer_store_dword v172, off, s[40:43], s25 sc1
L_fb_np3:
    s_barrier
    s_barrier
    s_mov_b32 s25, 4960256
    s_call_b64 s[76:77], L_fb_eval
    s_barrier
    s_barrier
    s_memrealtime s[98:99]
    s_and_b32 s25, s23, 3
    s_add_i32 s25, s25, 1
    s_max_i32 s25, s25, 0
    s_cmp_gt_i32 s25, 9
    s_cselect_b32 s25, 0, s25
    s_mul_i32 s25, s25, s24
    s_mul_i32 s25, s25, 14
    s_waitcnt lgkmcnt(0)
    s_sub_u32 s98, s98, s25
    s_cmp_lt_u32 s2, 8
    s_cbranch_scc0 L_fb_np4
    v_mov_b32 v172, s98
    s_lshl_b32 s25, s2, 12
    s_add_u32 s25, s25, 5029888
    buffer_store_dword v172, off, s[40:43], s25 sc1
L_fb_np4:
    s_barrier
    s_barrier
    s_mov_b32 s25, 5029888
    s_call_b64 s[76:77], L_fb_eval
    s_barrier
    s_barrier
    s_memrealtime s[98:99]
    s_waitcnt lgkmcnt(0)
    s_cmp_lt_u32 s2, 8
    s_cbranch_scc0 L_fb_np5
    v_mov_b32 v172, s98
    s_lshl_b32 s25, s2, 12
    s_add_u32 s25, s25, 5099520
    buffer_store_dword v172, off, s[40:43], s25 sc1
L_fb_np5:
    s_barrier
    s_barrier
    s_mov_b32 s25, 5099520
    s_call_b64 s[76:77], L_fb_eval
    s_barrier
    s_barrier
    buffer_load_dword v168, off, s[40:43], s73 offset:128 nt
    s_mov_b32 s36, s16
    s_mov_b32 s37, s17
    s_mov_b32 s38, 4194304
    s_mov_b32 s39, 0x20000
    s_lshl_b32 s25, s23, 15
    buffer_load_dword v169, off, s[36:39], s25 nt
L_ct_go:
    s_mov_b32 s52, 28
    s_cmp_eq_u32 s24, 0
    s_cselect_b32 s53, 31, 33
    s_mul_i32 s27, s24, 1
    s_sub_u32 s27, s53, s27
L_ct_loop:
    s_barrier
    s_add_u32 s52, s52, 1
    s_cmp_lt_u32 s52, s27
    s_cbranch_scc1 L_ct_loop
    s_cmp_eq_u32 s24, 0
    s_cbranch_scc0 L_ct_owner
    s_barrier
    buffer_store_dwordx2 v[170:171], off, s[40:43], s73 offset:16 sc1
    s_branch L_fin
L_ct_owner:
    s_and_b32 s55, s53, 3
    s_lshl_b32 s55, s55, 15
    buffer_load_dwordx2 v[168:169], off, s[40:43], s73 offset:16 sc1
    s_barrier
    s_branch L_ct_p2
L_ct_poll:
    buffer_load_dwordx2 v[168:169], off, s[40:43], s73 offset:16 sc1
L_ct_p2:
    s_waitcnt vmcnt(0)
    v_cmp_eq_u64 vcc, s[96:97], v[168:169]
    s_cbranch_vccz L_ct_poll
L_ct_fetch:
    s_mov_b64 exec, -1
    s_mov_b32 m0, 143360
    s_add_u32 s25, s61, 32768
    buffer_load_dwordx4 v166, s[40:43], s25 offen offset:0 sc1 lds
    buffer_load_dwordx4 v166, s[40:43], s25 offen offset:1024 sc1 lds
    buffer_load_dwordx4 v166, s[40:43], s25 offen offset:2048 sc1 lds
    buffer_load_dwordx4 v166, s[40:43], s25 offen offset:3072 sc1 lds
    s_add_u32 s26, s55, 32768
L_ct_f2:
    s_mov_b32 m0, s55
    s_add_u32 s55, s55, 4096
    buffer_load_dwordx4 v166, s[40:43], s61 offen offset:0 sc1 lds
    buffer_load_dwordx4 v166, s[40:43], s61 offen offset:1024 sc1 lds
    buffer_load_dwordx4 v166, s[40:43], s61 offen offset:2048 sc1 lds
    buffer_load_dwordx4 v166, s[40:43], s61 offen offset:3072 sc1 lds
    s_add_u32 s61, s61, 4096
    s_cmp_lt_u32 s55, s26
    s_cbranch_scc1 L_ct_f2
L_ct_last:
    s_waitcnt vmcnt(0)
    s_barrier
    s_branch L_fin
L_fb_eval:
    s_mov_b64 exec, 0xffff
    v_lshlrev_b32 v2, 12, v0
    buffer_load_dword v3, v2, s[40:43], s25 offen
    s_waitcnt vmcnt(0)
    v_sub_u32 v3, s98, v3
    v_add_u32 v2, 500, v3
    v_mov_b32 v4, 1000
    v_cmp_lt_u32 vcc, v2, v4
    v_cvt_f32_i32 v3, v3
    s_nop 0
    v_cndmask_b32 v3, 0, v3, vcc
    s_bcnt1_i32_b64 s25, vcc
    s_max_u32 s25, s25, 1
    s_nop 1
    v_add_f32_dpp v3, v3, v3 row_ror:1 row_mask:0xf bank_mask:0xf
    s_nop 1
    v_add_f32_dpp v3, v3, v3 row_ror:2 row_mask:0xf bank_mask:0xf
    s_nop 1
    v_add_f32_dpp v3, v3, v3 row_ror:4 row_mask:0xf bank_mask:0xf
    s_nop 1
    v_add_f32_dpp v3, v3, v3 row_ror:8 row_mask:0xf bank_mask:0xf
    v_cvt_f32_u32 v4, s25
    v_rcp_f32 v4, v4
    s_nop 0
    v_mul_f32 v3, v3, v4
    v_mul_f32 v3, 0x3e124925, v3
    v_rndne_f32 v3, v3
    v_cvt_i32_f32 v3, v3
    s_nop 0
    v_readfirstlane_b32 s25, v3
    s_mul_i32 s26, s24, 6
    s_sub_i32 s25, s26, s25
    s_add_i32 s25, s25, 10
    s_max_i32 s25, s25, 0
    s_min_i32 s25, s25, 12
    s_bfm_b32 s25, s25, 0
    s_mov_b64 exec, 1
    v_mov_b32 v172, s25
    ds_write_b32 v7, v172 offset:8
    s_waitcnt lgkmcnt(0)
    s_setpc_b64 s[76:77]
L_ct_cas:
    s_memrealtime s[96:97]
    s_waitcnt lgkmcnt(0)
    s_or_b32 s97, s97, 0x40000000
    s_mov_b64 s[44:45], s[96:97]
    s_mov_b64 s[46:47], 0
    s_atomic_cmpswap_x2 s[44:47], s[18:19], 0xf8 glc
    s_waitcnt lgkmcnt(0)
    s_cmp_eq_u64 s[44:45], 0
    s_cselect_b64 s[96:97], s[96:97], s[44:45]
    s_setpc_b64 s[76:77]
L_end:
.section .rodata,"a"
.p2align 6
.amdhsa_kernel standalone__tree_speculative_verify_tree_attention_over_candidate_token_tree__sampling_kernel
  .amdhsa_next_free_vgpr 256
  .amdhsa_next_free_sgpr 100
  .amdhsa_accum_offset 192
  .amdhsa_group_segment_fixed_size 0
  .amdhsa_kernarg_size 72
  .amdhsa_user_sgpr_count 2
  .amdhsa_user_sgpr_kernarg_segment_ptr 1
  .amdhsa_system_sgpr_workgroup_id_x 1
.end_amdhsa_kernel
```
